```python
import torch

def _softmax(x, axis=-1):
    return torch.softmax(x, dim=axis)
def _gelu(x):
    return torch.nn.functional.gelu(x, approximate="tanh")
def _silu(x):
    return torch.nn.functional.silu(x)
def _sigmoid(x):
    return torch.sigmoid(x)
def _layernorm(x, axis=-1, eps=1e-5):
    m = x.mean(dim=axis, keepdim=True)
    v = x.var(dim=axis, keepdim=True, unbiased=False)
    return (x - m) / torch.sqrt(v + eps)
def _scatter_add(tgt, idx, src, axis=0):
    return tgt.clone().index_add_(axis, idx, src)
def _segment_sum(src, seg, n):
    out = torch.zeros((n,) + src.shape[1:], dtype=src.dtype)
    return out.index_add_(0, seg, src)
def _pad(x, pw):
    flat = tuple(v for pair in reversed(pw) for v in pair)
    return torch.nn.functional.pad(x, flat)

kernel_name = 'sequential_preLN__compressed_kv_cla__swiglu_ffn__decode'

def setup_inputs():

    _w = (lambda a: (lambda t: t.to(torch.bfloat16) if t.is_floating_point() else t)(torch.as_tensor(a)))
    def _A_setup():
        B, H, Sq, Sk, D, M = 2, 32, 1, 16384, 128, 576
        Dc = 4 * D
        return {
            "x": _w((lambda *s: torch.randn(*s, dtype=torch.bfloat16) * 0.05)(B, Sq, M)),
            "c_kv": _w((lambda *s: torch.randn(*s, dtype=torch.bfloat16) * 0.4)(B, Sk, Dc)),
            "w_q": _w((lambda *s: torch.randn(*s, dtype=torch.bfloat16) * 3.2)(M, H, D) * (M ** -0.5)),
            "w_uk": _w((lambda *s: torch.randn(*s, dtype=torch.bfloat16) * 3.2)(Dc, H, D) * (Dc ** -0.5)),
            "w_uv": _w((lambda *s: torch.randn(*s, dtype=torch.bfloat16) * 0.4)(Dc, H, D) * (Dc ** -0.5)),
            "w_o": _w((lambda *s: torch.randn(*s, dtype=torch.bfloat16) * 0.4)(H, D, M) * ((H * D) ** -0.5)),
        }
    _A_in = _A_setup()

    def _B_setup():
        B, S, D, F = 2, 1, 576, 4608
        return {
            "x": _w((lambda *s: torch.randn(*s, dtype=torch.bfloat16) * 0.05)(B, S, D)),
            "w_gate": _w((lambda *s: torch.randn(*s, dtype=torch.bfloat16) * 0.05)(D, F)),
            "w_up": _w((lambda *s: torch.randn(*s, dtype=torch.bfloat16) * 0.05)(D, F)),
            "w_down": _w((lambda *s: torch.randn(*s, dtype=torch.bfloat16) * 0.05)(F, D)),
        }
    _B_in = _B_setup()

    return {
        "A_x": _A_in["x"],
        "A_c_kv": _A_in["c_kv"],
        "A_w_q": _A_in["w_q"],
        "A_w_uk": _A_in["w_uk"],
        "A_w_uv": _A_in["w_uv"],
        "A_w_o": _A_in["w_o"],
        "B_x": _B_in["x"],
        "B_w_gate": _B_in["w_gate"],
        "B_w_up": _B_in["w_up"],
        "B_w_down": _B_in["w_down"],
    }

def reference(A_x, A_c_kv, A_w_q, A_w_uk, A_w_uv, A_w_o, B_x, B_w_gate, B_w_up, B_w_down):
    def _A_ref(x, c_kv, w_q, w_uk, w_uv, w_o):
        B, Sq, M = x.shape[0], x.shape[1], x.shape[2]
        Sk = c_kv.shape[1]
        H, D = w_q.shape[1], w_q.shape[2]
        q = torch.einsum("bqm,mhd->bhqd", x, w_q)
        k = torch.einsum("bkc,chd->bhkd", c_kv, w_uk)
        v = torch.einsum("bkc,chd->bhkd", c_kv, w_uv)
        scores = torch.einsum("bhqd,bhkd->bhqk", q, k) * (D ** -0.5)
        off = Sk - Sq
        qi = torch.arange(Sq)[:, None]
        kj = torch.arange(Sk)[None, :]
        cmask = kj <= (qi + off)
        scores = torch.where(cmask[None, None], scores, -1e9)
        p = _softmax(scores, axis=-1)
        ctx = torch.einsum("bhqk,bhkd->bhqd", p, v)
        return torch.einsum("bhqd,hdm->bqm", ctx, w_o)

    def _B_ref(x, w_gate, w_up, w_down):
        g = _silu(x @ w_gate)
        u = x @ w_up
        return (g * u) @ w_down

    x = A_x
    h = x + _A_ref(_layernorm(x, axis=-1), A_c_kv, A_w_q, A_w_uk, A_w_uv, A_w_o)
    h2 = h + _B_ref(_layernorm(h, axis=-1), B_w_gate, B_w_up, B_w_down)
    return h2
```

```asm
; @launch kernel=k_main_kernel grid=(256,1,1) block=(512,1,1) lds=160848
.amdgcn_target "amdgcn-amd-amdhsa--gfx950"
.text
.globl k_main_kernel
.p2align 8
.type k_main_kernel,@function
k_main_kernel:
    s_cmp_ge_u32 s2, 256
    s_cbranch_scc1 k_main_kernel_end
    s_load_dwordx2 s[4:5], s[0:1], 8
    s_load_dwordx2 s[10:11], s[0:1], 96
    v_lshrrev_b32 v1, 6, v0
    s_nop 0
    v_readfirstlane_b32 s20, v1
    v_and_b32 v1, 63, v0
    v_mov_b32 v2, 0
    v_lshlrev_b32 v3, 2, v1
    v_cmp_gt_u32 vcc, 20, v0
    s_and_saveexec_b64 s[48:49], vcc
    ds_write_b32 v3, v2 offset:9216
    s_mov_b64 exec, s[48:49]
    s_waitcnt lgkmcnt(0)
    s_barrier
    s_cmp_ge_u32 s20, 4
    s_cbranch_scc1 k_main_kernel_teamB1
    s_load_dwordx2 s[12:13], s[0:1], 0
    s_load_dwordx2 s[14:15], s[0:1], 16
    s_load_dwordx2 s[16:17], s[0:1], 24
    s_load_dwordx2 s[18:19], s[0:1], 88
    s_load_dwordx2 s[68:69], s[0:1], 56
    s_load_dwordx2 s[70:71], s[0:1], 64
    s_and_b32 s21, s2, 31
    s_lshr_b32 s22, s2, 5
    v_and_b32 v3, 15, v1
    v_lshrrev_b32 v4, 4, v1
    v_mov_b32 v224, 0
    v_mov_b32 v225, 1
    s_waitcnt lgkmcnt(0)
    s_mov_b32 s24, s12
    s_mov_b32 s25, s13
    s_mov_b32 s26, 2304
    s_mov_b32 s27, 0x00020000
    s_mov_b32 s28, s14
    s_mov_b32 s29, s15
    s_mov_b32 s30, 4718592
    s_mov_b32 s31, 0x00020000
    s_mov_b32 s32, s16
    s_mov_b32 s33, s17
    s_mov_b32 s34, 4194304
    s_mov_b32 s35, 0x00020000
    s_add_u32 s36, s10, 131072
    s_addc_u32 s37, s11, 0
    s_mov_b32 s38, 262144
    s_mov_b32 s39, 0x00020000
    s_mov_b32 s52, s18
    s_mov_b32 s53, s19
    s_mov_b32 s54, 256
    s_mov_b32 s55, 0x00020000
    s_mov_b32 s56, s10
    s_mov_b32 s57, s11
    s_mov_b32 s58, 65536
    s_mov_b32 s59, 0x00020000
    s_add_u32 s60, s10, 2097152
    s_addc_u32 s61, s11, 0
    s_mov_b32 s62, 8388608
    s_mov_b32 s63, 0x00020000
    s_add_u32 s64, s10, 1900544
    s_addc_u32 s65, s11, 0
    s_mov_b32 s66, 65536
    s_mov_b32 s67, 0x00020000
    s_mov_b32 s72, s68
    s_mov_b32 s73, s69
    s_mov_b32 s74, 5308416
    s_mov_b32 s75, 0x00020000
    s_mov_b32 s76, s70
    s_mov_b32 s77, s71
    s_mov_b32 s78, 5308416
    s_mov_b32 s79, 0x00020000
    s_add_u32 s80, s10, 1835008
    s_addc_u32 s81, s11, 0
    s_mov_b32 s82, 32768
    s_mov_b32 s83, 0x00020000
    s_add_u32 s88, s10, 524288
    s_addc_u32 s89, s11, 0
    s_mov_b32 s90, 1572864
    s_mov_b32 s91, 0x00020000
    v_lshlrev_b32 v252, 4, v1
    s_and_b32 s84, s2, 7
    s_lshl_b32 s84, s84, 11
    s_and_b32 s23, s20, 1
    s_mul_i32 s23, s23, 1152
    v_lshlrev_b32 v2, 1, v1
    buffer_load_ushort v10, v2, s[24:27], s23 offen offset:0
    buffer_load_ushort v11, v2, s[24:27], s23 offen offset:128
    buffer_load_ushort v12, v2, s[24:27], s23 offen offset:256
    buffer_load_ushort v13, v2, s[24:27], s23 offen offset:384
    buffer_load_ushort v14, v2, s[24:27], s23 offen offset:512
    buffer_load_ushort v15, v2, s[24:27], s23 offen offset:640
    buffer_load_ushort v16, v2, s[24:27], s23 offen offset:768
    buffer_load_ushort v17, v2, s[24:27], s23 offen offset:896
    buffer_load_ushort v18, v2, s[24:27], s23 offen offset:1024
    v_lshlrev_b32 v6, 1, v4
    v_xor_b32 v6, v6, v3
    v_lshlrev_b32 v6, 4, v6
    v_lshl_add_u32 v6, v4, 13, v6
    s_and_b32 s40, s20, 2
    s_lshl_b32 s40, s40, 6
    v_xor_b32 v6, s40, v6
    s_mul_i32 s41, s22, 72
    s_lshl_b32 s42, s20, 2
    s_add_u32 s41, s41, s42
    s_lshl_b32 s41, s41, 13
    s_lshl_b32 s42, s21, 8
    s_add_u32 s41, s41, s42
    s_lshl_b32 s43, s20, 10
    s_add_u32 s43, s43, 142416
    s_mov_b32 m0, s43
    s_add_u32 s43, s43, 4096
    buffer_load_dwordx4 v6, s[28:31], s41 offen nt lds
    s_add_u32 s41, s41, 131072
    s_mov_b32 m0, s43
    s_add_u32 s43, s43, 4096
    buffer_load_dwordx4 v6, s[28:31], s41 offen nt lds
    s_add_u32 s41, s41, 131072
    s_mov_b32 m0, s43
    s_add_u32 s43, s43, 4096
    buffer_load_dwordx4 v6, s[28:31], s41 offen nt lds
    s_add_u32 s41, s41, 131072
    s_mov_b32 m0, s43
    s_add_u32 s43, s43, 4096
    buffer_load_dwordx4 v6, s[28:31], s41 offen nt lds
    s_add_u32 s41, s41, 131072
    s_cmp_ge_u32 s20, 2
    s_cbranch_scc1 k_main_kernel_wq42
    s_mov_b32 m0, s43
    s_add_u32 s43, s43, 4096
    buffer_load_dwordx4 v6, s[28:31], s41 offen nt lds
    s_add_u32 s41, s41, 131072
k_main_kernel_wq42:
    s_lshl_b32 s40, s22, 6
    s_lshl_b32 s41, s20, 4
    s_add_u32 s40, s40, s41
    v_add_u32 v7, s40, v3
    v_lshlrev_b32 v7, 13, v7
    v_lshl_add_u32 v7, v4, 4, v7
    s_lshl_b32 s41, s21, 8
    buffer_load_dwordx4 v[232:235], v7, s[32:35], s41 offen offset:0 nt
    buffer_load_dwordx4 v[236:239], v7, s[32:35], s41 offen offset:64 nt
    buffer_load_dwordx4 v[240:243], v7, s[32:35], s41 offen offset:128 nt
    buffer_load_dwordx4 v[244:247], v7, s[32:35], s41 offen offset:192 nt
    s_or_b32 s44, s20, s2
    s_cmp_lg_u32 s44, 0
    s_cbranch_scc1 k_main_kernel_non3
    s_mov_b64 exec, 1
    s_memrealtime s[86:87]
    s_waitcnt lgkmcnt(0)
    s_or_b32 s86, s86, 1
    v_mov_b32 v226, s86
    v_mov_b32 v227, s87
    buffer_store_dwordx2 v[226:227], v224, s[52:55], 0 offen sc1
    s_mov_b64 exec, -1
k_main_kernel_non3:
    v_mov_b32 v28, -1
    v_mov_b32 v29, -1
    v_mov_b32 v30, -1
    v_mov_b32 v31, -1
    v_lshlrev_b32 v9, 4, v0
    s_mul_i32 s45, s2, 5120
    buffer_store_dwordx4 v[28:31], v9, s[88:91], s45 offen sc1
    s_add_u32 s45, s45, 4096
    v_cmp_gt_u32 vcc, 64, v0
    s_and_saveexec_b64 s[48:49], vcc
    buffer_store_dwordx4 v[28:31], v9, s[88:91], s45 offen sc1
    s_mov_b64 exec, s[48:49]
    s_lshl_b32 s45, s2, 8
    s_add_u32 s45, s45, 0x150000
    v_cmp_gt_u32 vcc, 16, v0
    s_and_saveexec_b64 s[48:49], vcc
    buffer_store_dwordx4 v[28:31], v9, s[88:91], s45 offen sc1
    s_mov_b64 exec, s[48:49]
    s_waitcnt vmcnt(9)
    buffer_load_dwordx2 v[226:227], v224, s[52:55], 0 offen sc1
    v_lshlrev_b32 v10, 16, v10
    v_lshlrev_b32 v11, 16, v11
    v_lshlrev_b32 v12, 16, v12
    v_lshlrev_b32 v13, 16, v13
    v_lshlrev_b32 v14, 16, v14
    v_lshlrev_b32 v15, 16, v15
    v_lshlrev_b32 v16, 16, v16
    v_lshlrev_b32 v17, 16, v17
    v_lshlrev_b32 v18, 16, v18
    v_add_f32 v20, v10, v11
    v_add_f32 v20, v20, v12
    v_add_f32 v20, v20, v13
    v_add_f32 v20, v20, v14
    v_add_f32 v20, v20, v15
    v_add_f32 v20, v20, v16
    v_add_f32 v20, v20, v17
    v_add_f32 v20, v20, v18
    s_nop 1
    v_add_f32_dpp v20, v20, v20 quad_perm:[1,0,3,2] row_mask:0xf bank_mask:0xf
    s_nop 1
    v_add_f32_dpp v20, v20, v20 quad_perm:[2,3,0,1] row_mask:0xf bank_mask:0xf
    s_nop 1
    v_add_f32_dpp v20, v20, v20 row_half_mirror row_mask:0xf bank_mask:0xf
    s_nop 1
    v_add_f32_dpp v20, v20, v20 row_mirror row_mask:0xf bank_mask:0xf
    v_mov_b32 v21, v20
    s_nop 1
    v_permlane16_swap_b32 v20, v21
    s_nop 0
    v_add_f32 v20, v20, v21
    v_mov_b32 v21, v20
    s_nop 1
    v_permlane32_swap_b32 v20, v21
    s_nop 0
    v_add_f32 v20, v20, v21
    v_mul_f32 v20, 987991609, v20
    v_sub_f32 v10, v10, v20
    v_sub_f32 v11, v11, v20
    v_sub_f32 v12, v12, v20
    v_sub_f32 v13, v13, v20
    v_sub_f32 v14, v14, v20
    v_sub_f32 v15, v15, v20
    v_sub_f32 v16, v16, v20
    v_sub_f32 v17, v17, v20
    v_sub_f32 v18, v18, v20
    v_mul_f32 v22, v10, v10
    v_fmac_f32 v22, v11, v11
    v_fmac_f32 v22, v12, v12
    v_fmac_f32 v22, v13, v13
    v_fmac_f32 v22, v14, v14
    v_fmac_f32 v22, v15, v15
    v_fmac_f32 v22, v16, v16
    v_fmac_f32 v22, v17, v17
    v_fmac_f32 v22, v18, v18
    s_nop 1
    v_add_f32_dpp v22, v22, v22 quad_perm:[1,0,3,2] row_mask:0xf bank_mask:0xf
    s_nop 1
    v_add_f32_dpp v22, v22, v22 quad_perm:[2,3,0,1] row_mask:0xf bank_mask:0xf
    s_nop 1
    v_add_f32_dpp v22, v22, v22 row_half_mirror row_mask:0xf bank_mask:0xf
    s_nop 1
    v_add_f32_dpp v22, v22, v22 row_mirror row_mask:0xf bank_mask:0xf
    v_mov_b32 v21, v22
    s_nop 1
    v_permlane16_swap_b32 v22, v21
    s_nop 0
    v_add_f32 v22, v22, v21
    v_mov_b32 v21, v22
    s_nop 1
    v_permlane32_swap_b32 v22, v21
    s_nop 0
    v_add_f32 v22, v22, v21
    v_mov_b32 v23, 925353388
    v_fmac_f32 v23, 987991609, v22
    v_rsq_f32 v23, v23
    v_add_u32 v24, s23, v2
    v_mul_f32 v10, v10, v23
    v_cvt_pk_bf16_f32 v25, v10, v10
    v_lshlrev_b32 v27, 16, v25
    v_sub_f32 v27, v10, v27
    v_cvt_pk_bf16_f32 v26, v27, v27
    ds_write_b16 v24, v25 offset:0
    ds_write_b16 v24, v26 offset:2304
    v_mul_f32 v11, v11, v23
    v_cvt_pk_bf16_f32 v25, v11, v11
    v_lshlrev_b32 v27, 16, v25
    v_sub_f32 v27, v11, v27
    v_cvt_pk_bf16_f32 v26, v27, v27
    ds_write_b16 v24, v25 offset:128
    ds_write_b16 v24, v26 offset:2432
    v_mul_f32 v12, v12, v23
    v_cvt_pk_bf16_f32 v25, v12, v12
    v_lshlrev_b32 v27, 16, v25
    v_sub_f32 v27, v12, v27
    v_cvt_pk_bf16_f32 v26, v27, v27
    ds_write_b16 v24, v25 offset:256
    ds_write_b16 v24, v26 offset:2560
    v_mul_f32 v13, v13, v23
    v_cvt_pk_bf16_f32 v25, v13, v13
    v_lshlrev_b32 v27, 16, v25
    v_sub_f32 v27, v13, v27
    v_cvt_pk_bf16_f32 v26, v27, v27
    ds_write_b16 v24, v25 offset:384
    ds_write_b16 v24, v26 offset:2688
    v_mul_f32 v14, v14, v23
    v_cvt_pk_bf16_f32 v25, v14, v14
    v_lshlrev_b32 v27, 16, v25
    v_sub_f32 v27, v14, v27
    v_cvt_pk_bf16_f32 v26, v27, v27
    ds_write_b16 v24, v25 offset:512
    ds_write_b16 v24, v26 offset:2816
    v_mul_f32 v15, v15, v23
    v_cvt_pk_bf16_f32 v25, v15, v15
    v_lshlrev_b32 v27, 16, v25
    v_sub_f32 v27, v15, v27
    v_cvt_pk_bf16_f32 v26, v27, v27
    ds_write_b16 v24, v25 offset:640
    ds_write_b16 v24, v26 offset:2944
    v_mul_f32 v16, v16, v23
    v_cvt_pk_bf16_f32 v25, v16, v16
    v_lshlrev_b32 v27, 16, v25
    v_sub_f32 v27, v16, v27
    v_cvt_pk_bf16_f32 v26, v27, v27
    ds_write_b16 v24, v25 offset:768
    ds_write_b16 v24, v26 offset:3072
    v_mul_f32 v17, v17, v23
    v_cvt_pk_bf16_f32 v25, v17, v17
    v_lshlrev_b32 v27, 16, v25
    v_sub_f32 v27, v17, v27
    v_cvt_pk_bf16_f32 v26, v27, v27
    ds_write_b16 v24, v25 offset:896
    ds_write_b16 v24, v26 offset:3200
    v_mul_f32 v18, v18, v23
    v_cvt_pk_bf16_f32 v25, v18, v18
    v_lshlrev_b32 v27, 16, v25
    v_sub_f32 v27, v18, v27
    v_cvt_pk_bf16_f32 v26, v27, v27
    ds_write_b16 v24, v25 offset:1024
    ds_write_b16 v24, v26 offset:3328
    s_waitcnt vmcnt(6)
    s_mov_b64 exec, 1
    ds_add_u32 v224, v225 offset:9220
    s_mov_b64 exec, -1
k_main_kernel_spin4:
    ds_read_b32 v229, v224 offset:9220
    s_waitcnt lgkmcnt(0)
    v_readfirstlane_b32 s44, v229
    s_cmp_lt_u32 s44, 4
    s_cbranch_scc1 k_main_kernel_spin4
    v_and_b32 v8, 3, v1
    v_mul_u32_u24 v8, 1152, v8
    v_lshl_add_u32 v8, v4, 4, v8
    s_mul_i32 s40, s22, 144
    v_add_u32 v8, s40, v8
    ds_read_b128 v[28:31], v8 offset:0
    ds_read_b128 v[32:35], v8 offset:64
    ds_read_b128 v[36:39], v8 offset:128
    v_lshrrev_b32 v9, 2, v3
    v_lshl_add_u32 v10, v4, 3, v9
    v_lshlrev_b32 v10, 8, v10
    v_and_b32 v11, 1, v4
    v_lshlrev_b32 v11, 3, v11
    v_lshl_or_b32 v11, v9, 1, v11
    v_bfe_u32 v12, v3, 1, 1
    s_lshl_b32 s46, s20, 2
    v_add_u32 v12, s46, v12
    v_and_b32 v13, 1, v3
    v_lshlrev_b32 v13, 3, v13
    s_mov_b32 s47, 142416
    v_add3_u32 v10, v10, v13, s47
    v_lshlrev_b32 v19, 8, v9
    s_mov_b32 s47, 158800
    v_add3_u32 v19, v19, v13, s47
    v_lshlrev_b32 v18, 1, v9
    v_add_u32 v14, 0, v12
    v_xor_b32 v15, v14, v11
    v_lshl_add_u32 v15, v15, 4, v10
    v_xor_b32 v16, v14, v18
    v_lshl_add_u32 v16, v16, 4, v19
    ds_read_b64_tr_b16 v[40:41], v15 offset:0
    ds_read_b64_tr_b16 v[42:43], v15 offset:1024
    ds_read_b64_tr_b16 v[44:45], v15 offset:8192
    ds_read_b64_tr_b16 v[46:47], v15 offset:9216
    ds_read_b64_tr_b16 v[48:49], v16
    ds_read_b64_tr_b16 v[50:51], v16 offset:1024
    v_add_u32 v14, 2, v12
    v_xor_b32 v15, v14, v11
    v_lshl_add_u32 v15, v15, 4, v10
    v_xor_b32 v16, v14, v18
    v_lshl_add_u32 v16, v16, 4, v19
    ds_read_b64_tr_b16 v[52:53], v15 offset:0
    ds_read_b64_tr_b16 v[54:55], v15 offset:1024
    ds_read_b64_tr_b16 v[56:57], v15 offset:8192
    ds_read_b64_tr_b16 v[58:59], v15 offset:9216
    ds_read_b64_tr_b16 v[60:61], v16
    ds_read_b64_tr_b16 v[62:63], v16 offset:1024
    v_cmp_gt_u32 vcc, 16, v1
    s_waitcnt lgkmcnt(0)
    v_cndmask_b32 v36, 0, v36, vcc
    v_cndmask_b32 v37, 0, v37, vcc
    v_cndmask_b32 v38, 0, v38, vcc
    v_cndmask_b32 v39, 0, v39, vcc
    s_nop 1
    v_mfma_f32_16x16x32_bf16 v[64:67], v[28:31], v[40:43], 0
    v_mfma_f32_16x16x32_bf16 v[64:67], v[32:35], v[44:47], v[64:67]
    v_mfma_f32_16x16x32_bf16 v[64:67], v[36:39], v[48:51], v[64:67]
    v_mfma_f32_16x16x32_bf16 v[68:71], v[28:31], v[52:55], 0
    v_mfma_f32_16x16x32_bf16 v[68:71], v[32:35], v[56:59], v[68:71]
    v_mfma_f32_16x16x32_bf16 v[68:71], v[36:39], v[60:63], v[68:71]
    s_lshl_b32 s46, s22, 15
    s_lshl_b32 s47, s21, 9
    s_add_u32 s46, s46, s47
    s_lshl_b32 s47, s20, 7
    s_add_u32 s46, s46, s47
    v_lshl_add_u32 v27, v3, 2, s46
    s_mov_b32 s47, 16384
    s_nop 4
    v_add_f32 v8, v64, v66
    v_add_f32 v9, v65, v67
    v_add_f32 v10, v68, v70
    v_add_f32 v11, v69, v71
    s_and_saveexec_b64 s[48:49], vcc
    buffer_store_dword v8, v27, s[36:39], 0 offen sc1
    buffer_store_dword v9, v27, s[36:39], s47 offen sc1
    buffer_store_dword v10, v27, s[36:39], 0 offen offset:64 sc1
    buffer_store_dword v11, v27, s[36:39], s47 offen offset:64 sc1
    s_mov_b64 exec, s[48:49]
    s_mov_b32 s44, 0
    s_waitcnt vmcnt(4)
k_main_kernel_nw5:
    v_readfirstlane_b32 s86, v226
    v_readfirstlane_b32 s87, v227
    s_add_u32 s44, s44, 1
    s_cmp_gt_u32 s44, 40000
    s_cbranch_scc1 k_main_kernel_nf6
    s_cmp_eq_u32 s86, 0
    s_cbranch_scc0 k_main_kernel_nf6
    s_sleep 2
    buffer_load_dwordx2 v[226:227], v224, s[52:55], 0 offen sc1
    s_waitcnt vmcnt(0)
    s_branch k_main_kernel_nw5
k_main_kernel_nf6:
    s_or_b32 s86, s86, 1
    s_waitcnt vmcnt(0)
    s_mov_b64 exec, 1
    ds_add_rtn_u32 v226, v224, v225 offset:9224
    s_waitcnt lgkmcnt(0)
    v_readfirstlane_b32 s44, v226
    s_mov_b64 exec, 0xff
    s_cmp_lg_u32 s44, 3
    s_cbranch_scc1 k_main_kernel_pub7
    s_lshl_b32 s44, s2, 3
    s_add_u32 s44, s44, 0
    v_lshlrev_b32 v226, 11, v1
    v_mov_b32 v228, s86
    v_mov_b32 v229, s87
    buffer_store_dwordx2 v[228:229], v226, s[80:83], s44 offen sc1
k_main_kernel_pub7:
    s_mov_b64 exec, -1
    s_lshl_b32 s46, s21, 3
    v_lshl_add_u32 v88, v1, 8, s46
    s_cmp_lg_u32 s20, 0
    s_cbranch_scc1 k_main_kernel_spo10
    s_mov_b32 s44, 0
    s_mov_b64 exec, 0xff
k_main_kernel_sp8:
    buffer_load_dwordx2 v[80:81], v88, s[80:83], s84 offen sc1
    s_waitcnt vmcnt(0)
    v_xor_b32 v80, s86, v80
    v_xor_b32 v81, s87, v81
    v_or_b32 v80, v80, v81
    v_cmp_ne_u32 vcc, 0, v80
    s_add_u32 s44, s44, 1
    s_cmp_gt_u32 s44, 40000
    s_cbranch_scc1 k_main_kernel_spd9
    s_cbranch_vccz k_main_kernel_spd9
    s_sleep 3
    s_branch k_main_kernel_sp8
k_main_kernel_spd9:
    s_mov_b64 exec, -1
    ds_write_b32 v224, v225 offset:9264
    s_branch k_main_kernel_spe11
k_main_kernel_spo10:
k_main_kernel_lw12:
    s_sleep 1
    ds_read_b32 v80, v224 offset:9264
    s_waitcnt lgkmcnt(0)
    v_readfirstlane_b32 s44, v80
    s_cmp_lt_u32 s44, 1
    s_cbranch_scc1 k_main_kernel_lw12
k_main_kernel_spe11:
    v_lshrrev_b32 v5, 7, v0
    v_and_b32 v6, 127, v0
    v_lshlrev_b32 v8, 14, v5
    v_lshl_add_u32 v8, v6, 2, v8
    s_lshl_b32 s46, s21, 9
    buffer_load_dword v10, v8, s[36:39], s46 offen sc1
    s_add_u32 s46, s46, 32768
    buffer_load_dword v11, v8, s[36:39], s46 offen sc1
    s_add_u32 s46, s46, 32768
    buffer_load_dword v12, v8, s[36:39], s46 offen sc1
    s_add_u32 s46, s46, 32768
    buffer_load_dword v13, v8, s[36:39], s46 offen sc1
    s_add_u32 s46, s46, 32768
    buffer_load_dword v14, v8, s[36:39], s46 offen sc1
    s_add_u32 s46, s46, 32768
    buffer_load_dword v15, v8, s[36:39], s46 offen sc1
    s_add_u32 s46, s46, 32768
    buffer_load_dword v16, v8, s[36:39], s46 offen sc1
    s_add_u32 s46, s46, 32768
    buffer_load_dword v17, v8, s[36:39], s46 offen sc1
    s_add_u32 s46, s46, 32768
    v_lshlrev_b32 v24, 8, v5
    v_lshl_add_u32 v24, v6, 1, v24
    s_waitcnt vmcnt(0)
    v_add_f32 v10, v10, v11
    v_add_f32 v10, v10, v12
    v_add_f32 v10, v10, v13
    v_add_f32 v10, v10, v14
    v_add_f32 v10, v10, v15
    v_add_f32 v10, v10, v16
    v_add_f32 v10, v10, v17
    v_cvt_pk_bf16_f32 v25, v10, v10
    v_lshlrev_b32 v27, 16, v25
    v_sub_f32 v27, v10, v27
    v_cvt_pk_bf16_f32 v26, v27, v27
    ds_write_b16 v24, v25 offset:4608
    ds_write_b16 v24, v26 offset:5120
    s_mov_b64 exec, 1
    ds_add_u32 v224, v225 offset:9228
    s_mov_b64 exec, -1
k_main_kernel_spin13:
    ds_read_b32 v226, v224 offset:9228
    s_waitcnt lgkmcnt(0)
    v_readfirstlane_b32 s44, v226
    s_cmp_lt_u32 s44, 4
    s_cbranch_scc1 k_main_kernel_spin13
    v_and_b32 v8, 3, v1
    v_lshlrev_b32 v8, 8, v8
    v_lshl_add_u32 v8, v4, 4, v8
    ds_read_b128 v[28:31], v8 offset:4608
    ds_read_b128 v[32:35], v8 offset:4672
    ds_read_b128 v[36:39], v8 offset:4736
    ds_read_b128 v[40:43], v8 offset:4800
    s_waitcnt vmcnt(0) lgkmcnt(0)
    v_mfma_f32_16x16x32_bf16 v[64:67], v[28:31], v[232:235], 0
    v_mfma_f32_16x16x32_bf16 v[64:67], v[32:35], v[236:239], v[64:67]
    v_mfma_f32_16x16x32_bf16 v[64:67], v[36:39], v[240:243], v[64:67]
    v_mfma_f32_16x16x32_bf16 v[64:67], v[40:43], v[244:247], v[64:67]
    s_lshl_b32 s46, s22, 2
    s_add_u32 s46, s46, s20
    s_lshl_b32 s46, s46, 10
    s_lshl_b32 s47, s21, 4
    s_add_u32 s46, s46, s47
    v_lshrrev_b32 v12, 1, v1
    v_lshlrev_b32 v12, 15, v12
    v_and_b32 v13, 1, v1
    v_lshl_add_u32 v12, v13, 9, v12
    s_lshl_b32 s47, s20, 6
    v_lshl_add_u32 v13, v3, 1, s47
    v_lshl_add_u32 v14, v1, 4, s47
    v_add_f32 v10, v64, v66
    v_add_f32 v11, v65, v67
    v_mul_f32 v10, 1040356334, v10
    v_mul_f32 v11, 1040356334, v11
    v_cvt_pk_bf16_f32 v10, v10, v11
    ds_write_b16 v13, v10 offset:5632
    ds_write_b16_d16_hi v13, v10 offset:5664
    s_mov_b64 exec, 0xf
    ds_read_b128 v[16:19], v14 offset:5632
    s_waitcnt lgkmcnt(0)
    buffer_store_dwordx4 v[16:19], v12, s[56:59], s46 offen sc1
    s_mov_b64 exec, -1
    s_waitcnt vmcnt(0)
    s_mov_b64 exec, 1
    ds_add_rtn_u32 v226, v224, v225 offset:9232
    s_waitcnt lgkmcnt(0)
    v_readfirstlane_b32 s44, v226
    s_mov_b64 exec, 0xff
    s_cmp_lg_u32 s44, 3
    s_cbranch_scc1 k_main_kernel_pub14
    s_lshl_b32 s44, s2, 3
    s_add_u32 s44, s44, 16384
    v_lshlrev_b32 v226, 11, v1
    v_mov_b32 v228, s86
    v_mov_b32 v229, s87
    buffer_store_dwordx2 v[228:229], v226, s[80:83], s44 offen sc1
k_main_kernel_pub14:
    s_mov_b64 exec, -1
    v_and_b32 v2, 31, v1
    v_lshrrev_b32 v3, 5, v1
    s_lshr_b32 s21, s2, 7
    s_lshl_b32 s22, s21, 15
    v_lshlrev_b32 v5, 4, v1
    s_lshl_b32 s41, s20, 5
    v_and_b32 v6, 16, v2
    v_and_b32 v7, 3, v2
    v_lshl_add_u32 v6, v7, 2, v6
    v_bfe_u32 v7, v2, 2, 1
    v_lshl_add_u32 v6, v7, 1, v6
    v_bfe_u32 v7, v2, 3, 1
    v_add_u32 v6, v6, v7
    v_add_u32 v6, s41, v6
    v_mul_u32_u24 v6, 1040, v6
    v_lshl_add_u32 v6, v3, 4, v6
    v_add_u32 v6, 9296, v6
    s_add_u32 s84, s84, 16384
    s_cmp_lg_u32 s20, 0
    s_cbranch_scc1 k_main_kernel_spo17
    s_mov_b32 s44, 0
k_main_kernel_sp15:
    buffer_load_dwordx4 v[244:247], v252, s[80:83], s84 offen sc1
    buffer_load_dwordx4 v[248:251], v252, s[80:83], s84 offen offset:1024 sc1
    s_waitcnt vmcnt(0)
    v_xor_b32 v244, s86, v244
    v_xor_b32 v245, s87, v245
    v_xor_b32 v246, s86, v246
    v_xor_b32 v247, s87, v247
    v_xor_b32 v248, s86, v248
    v_xor_b32 v249, s87, v249
    v_xor_b32 v250, s86, v250
    v_xor_b32 v251, s87, v251
    v_or3_b32 v244, v244, v245, v246
    v_or3_b32 v247, v247, v248, v249
    v_or3_b32 v244, v244, v250, v251
    v_or_b32 v244, v244, v247
    v_cmp_ne_u32 vcc, 0, v244
    s_add_u32 s44, s44, 1
    s_cmp_gt_u32 s44, 40000
    s_cbranch_scc1 k_main_kernel_spd16
    s_cbranch_vccz k_main_kernel_spd16
    s_sleep 3
    s_branch k_main_kernel_sp15
k_main_kernel_spd16:
    s_mov_b64 exec, -1
    ds_write_b32 v224, v225 offset:9268
    s_branch k_main_kernel_spe18
k_main_kernel_spo17:
k_main_kernel_lw19:
    s_sleep 1
    ds_read_b32 v244, v224 offset:9268
    s_waitcnt lgkmcnt(0)
    v_readfirstlane_b32 s44, v244
    s_cmp_lt_u32 s44, 1
    s_cbranch_scc1 k_main_kernel_lw19
k_main_kernel_spe18:
    buffer_load_dwordx4 v[96:99], v5, s[56:59], s22 offen offset:0 sc1
    buffer_load_dwordx4 v[100:103], v5, s[56:59], s22 offen offset:1024 sc1
    buffer_load_dwordx4 v[104:107], v5, s[56:59], s22 offen offset:2048 sc1
    buffer_load_dwordx4 v[108:111], v5, s[56:59], s22 offen offset:3072 sc1
    s_add_u32 s22, s22, 4096
    buffer_load_dwordx4 v[112:115], v5, s[56:59], s22 offen offset:0 sc1
    buffer_load_dwordx4 v[116:119], v5, s[56:59], s22 offen offset:1024 sc1
    buffer_load_dwordx4 v[120:123], v5, s[56:59], s22 offen offset:2048 sc1
    buffer_load_dwordx4 v[124:127], v5, s[56:59], s22 offen offset:3072 sc1
    s_add_u32 s22, s22, 4096
    buffer_load_dwordx4 v[128:131], v5, s[56:59], s22 offen offset:0 sc1
    buffer_load_dwordx4 v[132:135], v5, s[56:59], s22 offen offset:1024 sc1
    buffer_load_dwordx4 v[136:139], v5, s[56:59], s22 offen offset:2048 sc1
    buffer_load_dwordx4 v[140:143], v5, s[56:59], s22 offen offset:3072 sc1
    s_add_u32 s22, s22, 4096
    buffer_load_dwordx4 v[144:147], v5, s[56:59], s22 offen offset:0 sc1
    buffer_load_dwordx4 v[148:151], v5, s[56:59], s22 offen offset:1024 sc1
    buffer_load_dwordx4 v[152:155], v5, s[56:59], s22 offen offset:2048 sc1
    buffer_load_dwordx4 v[156:159], v5, s[56:59], s22 offen offset:3072 sc1
    s_add_u32 s22, s22, 4096
    buffer_load_dwordx4 v[160:163], v5, s[56:59], s22 offen offset:0 sc1
    buffer_load_dwordx4 v[164:167], v5, s[56:59], s22 offen offset:1024 sc1
    buffer_load_dwordx4 v[168:171], v5, s[56:59], s22 offen offset:2048 sc1
    buffer_load_dwordx4 v[172:175], v5, s[56:59], s22 offen offset:3072 sc1
    s_add_u32 s22, s22, 4096
    buffer_load_dwordx4 v[176:179], v5, s[56:59], s22 offen offset:0 sc1
    buffer_load_dwordx4 v[180:183], v5, s[56:59], s22 offen offset:1024 sc1
    buffer_load_dwordx4 v[184:187], v5, s[56:59], s22 offen offset:2048 sc1
    buffer_load_dwordx4 v[188:191], v5, s[56:59], s22 offen offset:3072 sc1
    s_add_u32 s22, s22, 4096
    buffer_load_dwordx4 v[192:195], v5, s[56:59], s22 offen offset:0 sc1
    buffer_load_dwordx4 v[196:199], v5, s[56:59], s22 offen offset:1024 sc1
    buffer_load_dwordx4 v[200:203], v5, s[56:59], s22 offen offset:2048 sc1
    buffer_load_dwordx4 v[204:207], v5, s[56:59], s22 offen offset:3072 sc1
    s_add_u32 s22, s22, 4096
    buffer_load_dwordx4 v[208:211], v5, s[56:59], s22 offen offset:0 sc1
    buffer_load_dwordx4 v[212:215], v5, s[56:59], s22 offen offset:1024 sc1
    buffer_load_dwordx4 v[216:219], v5, s[56:59], s22 offen offset:2048 sc1
    buffer_load_dwordx4 v[220:223], v5, s[56:59], s22 offen offset:3072 sc1
k_main_kernel_lw20:
    ds_read_b32 v226, v224 offset:9216
    s_waitcnt lgkmcnt(0)
    v_readfirstlane_b32 s44, v226
    s_cmp_lt_u32 s44, 4
    s_cbranch_scc1 k_main_kernel_lw20
    ds_read_b128 v[32:35], v6 offset:0
    ds_read_b128 v[36:39], v6 offset:32
    ds_read_b128 v[40:43], v6 offset:64
    ds_read_b128 v[44:47], v6 offset:96
    ds_read_b128 v[48:51], v6 offset:128
    ds_read_b128 v[52:55], v6 offset:160
    ds_read_b128 v[56:59], v6 offset:192
    ds_read_b128 v[60:63], v6 offset:224
    ds_read_b128 v[64:67], v6 offset:256
    ds_read_b128 v[68:71], v6 offset:288
    ds_read_b128 v[72:75], v6 offset:320
    ds_read_b128 v[76:79], v6 offset:352
    ds_read_b128 v[80:83], v6 offset:384
    ds_read_b128 v[84:87], v6 offset:416
    ds_read_b128 v[88:91], v6 offset:448
    ds_read_b128 v[92:95], v6 offset:480
    s_waitcnt lgkmcnt(8)
    s_waitcnt vmcnt(28)
    v_mfma_f32_32x32x16_bf16 v[16:31], v[32:35], v[96:99], 0
    v_mfma_f32_32x32x16_bf16 v[16:31], v[36:39], v[100:103], v[16:31]
    v_mfma_f32_32x32x16_bf16 v[16:31], v[40:43], v[104:107], v[16:31]
    v_mfma_f32_32x32x16_bf16 v[16:31], v[44:47], v[108:111], v[16:31]
    s_waitcnt vmcnt(24)
    v_mfma_f32_32x32x16_bf16 v[16:31], v[48:51], v[112:115], v[16:31]
    v_mfma_f32_32x32x16_bf16 v[16:31], v[52:55], v[116:119], v[16:31]
    v_mfma_f32_32x32x16_bf16 v[16:31], v[56:59], v[120:123], v[16:31]
    v_mfma_f32_32x32x16_bf16 v[16:31], v[60:63], v[124:127], v[16:31]
    ds_read_b128 v[32:35], v6 offset:512
    ds_read_b128 v[36:39], v6 offset:544
    ds_read_b128 v[40:43], v6 offset:576
    ds_read_b128 v[44:47], v6 offset:608
    ds_read_b128 v[48:51], v6 offset:640
    ds_read_b128 v[52:55], v6 offset:672
    ds_read_b128 v[56:59], v6 offset:704
    ds_read_b128 v[60:63], v6 offset:736
    s_waitcnt lgkmcnt(8)
    s_waitcnt vmcnt(20)
    v_mfma_f32_32x32x16_bf16 v[16:31], v[64:67], v[128:131], v[16:31]
    v_mfma_f32_32x32x16_bf16 v[16:31], v[68:71], v[132:135], v[16:31]
    v_mfma_f32_32x32x16_bf16 v[16:31], v[72:75], v[136:139], v[16:31]
    v_mfma_f32_32x32x16_bf16 v[16:31], v[76:79], v[140:143], v[16:31]
    s_waitcnt vmcnt(16)
    v_mfma_f32_32x32x16_bf16 v[16:31], v[80:83], v[144:147], v[16:31]
    v_mfma_f32_32x32x16_bf16 v[16:31], v[84:87], v[148:151], v[16:31]
    v_mfma_f32_32x32x16_bf16 v[16:31], v[88:91], v[152:155], v[16:31]
    v_mfma_f32_32x32x16_bf16 v[16:31], v[92:95], v[156:159], v[16:31]
    ds_read_b128 v[64:67], v6 offset:768
    ds_read_b128 v[68:71], v6 offset:800
    ds_read_b128 v[72:75], v6 offset:832
    ds_read_b128 v[76:79], v6 offset:864
    ds_read_b128 v[80:83], v6 offset:896
    ds_read_b128 v[84:87], v6 offset:928
    ds_read_b128 v[88:91], v6 offset:960
    ds_read_b128 v[92:95], v6 offset:992
    s_waitcnt lgkmcnt(8)
    s_waitcnt vmcnt(12)
    v_mfma_f32_32x32x16_bf16 v[16:31], v[32:35], v[160:163], v[16:31]
    v_mfma_f32_32x32x16_bf16 v[16:31], v[36:39], v[164:167], v[16:31]
    v_mfma_f32_32x32x16_bf16 v[16:31], v[40:43], v[168:171], v[16:31]
    v_mfma_f32_32x32x16_bf16 v[16:31], v[44:47], v[172:175], v[16:31]
    s_waitcnt vmcnt(8)
    v_mfma_f32_32x32x16_bf16 v[16:31], v[48:51], v[176:179], v[16:31]
    v_mfma_f32_32x32x16_bf16 v[16:31], v[52:55], v[180:183], v[16:31]
    v_mfma_f32_32x32x16_bf16 v[16:31], v[56:59], v[184:187], v[16:31]
    v_mfma_f32_32x32x16_bf16 v[16:31], v[60:63], v[188:191], v[16:31]
    s_waitcnt lgkmcnt(0)
    s_waitcnt vmcnt(4)
    v_mfma_f32_32x32x16_bf16 v[16:31], v[64:67], v[192:195], v[16:31]
    v_mfma_f32_32x32x16_bf16 v[16:31], v[68:71], v[196:199], v[16:31]
    v_mfma_f32_32x32x16_bf16 v[16:31], v[72:75], v[200:203], v[16:31]
    v_mfma_f32_32x32x16_bf16 v[16:31], v[76:79], v[204:207], v[16:31]
    s_waitcnt vmcnt(0)
    v_mfma_f32_32x32x16_bf16 v[16:31], v[80:83], v[208:211], v[16:31]
    v_mfma_f32_32x32x16_bf16 v[16:31], v[84:87], v[212:215], v[16:31]
    v_mfma_f32_32x32x16_bf16 v[16:31], v[88:91], v[216:219], v[16:31]
    v_mfma_f32_32x32x16_bf16 v[16:31], v[92:95], v[220:223], v[16:31]
    s_nop 15
    v_max3_f32 v8, v16, v17, v18
    v_max3_f32 v8, v8, v19, v20
    v_max3_f32 v8, v8, v21, v22
    v_max3_f32 v8, v8, v23, v24
    v_max3_f32 v8, v8, v25, v26
    v_max3_f32 v8, v8, v27, v28
    v_max3_f32 v8, v8, v29, v30
    v_max_f32 v8, v8, v31
    v_mov_b32 v9, v8
    s_nop 1
    v_permlane32_swap_b32 v8, v9
    s_nop 0
    v_max_f32 v8, v8, v9
    s_lshl_b32 s43, s20, 2
    v_lshl_add_u32 v10, v2, 4, s43
    v_lshlrev_b32 v11, 4, v2
    ds_write_b32 v10, v8 offset:8192
    s_mov_b64 exec, 1
    ds_add_u32 v224, v225 offset:9236
    s_mov_b64 exec, -1
k_main_kernel_spin21:
    ds_read_b32 v226, v224 offset:9236
    s_waitcnt lgkmcnt(0)
    v_readfirstlane_b32 s44, v226
    s_cmp_lt_u32 s44, 4
    s_cbranch_scc1 k_main_kernel_spin21
    ds_read_b128 v[12:15], v11 offset:8192
    s_waitcnt lgkmcnt(0)
    v_max3_f32 v8, v12, v13, v14
    v_max_f32 v8, v8, v15
    v_sub_f32 v16, v16, v8
    v_sub_f32 v17, v17, v8
    v_sub_f32 v18, v18, v8
    v_sub_f32 v19, v19, v8
    v_sub_f32 v20, v20, v8
    v_sub_f32 v21, v21, v8
    v_sub_f32 v22, v22, v8
    v_sub_f32 v23, v23, v8
    v_sub_f32 v24, v24, v8
    v_sub_f32 v25, v25, v8
    v_sub_f32 v26, v26, v8
    v_sub_f32 v27, v27, v8
    v_sub_f32 v28, v28, v8
    v_sub_f32 v29, v29, v8
    v_sub_f32 v30, v30, v8
    v_sub_f32 v31, v31, v8
    v_exp_f32 v16, v16
    v_exp_f32 v17, v17
    v_exp_f32 v18, v18
    v_exp_f32 v19, v19
    v_exp_f32 v20, v20
    v_exp_f32 v21, v21
    v_exp_f32 v22, v22
    v_exp_f32 v23, v23
    v_exp_f32 v24, v24
    v_exp_f32 v25, v25
    v_exp_f32 v26, v26
    v_exp_f32 v27, v27
    v_exp_f32 v28, v28
    v_exp_f32 v29, v29
    v_exp_f32 v30, v30
    v_exp_f32 v31, v31
    s_nop 0
    v_add_f32 v9, v16, v17
    v_add_f32 v9, v9, v18
    v_add_f32 v9, v9, v19
    v_add_f32 v9, v9, v20
    v_add_f32 v9, v9, v21
    v_add_f32 v9, v9, v22
    v_add_f32 v9, v9, v23
    v_add_f32 v9, v9, v24
    v_add_f32 v9, v9, v25
    v_add_f32 v9, v9, v26
    v_add_f32 v9, v9, v27
    v_add_f32 v9, v9, v28
    v_add_f32 v9, v9, v29
    v_add_f32 v9, v9, v30
    v_add_f32 v9, v9, v31
    v_cvt_pk_bf16_f32 v32, v16, v17
    v_cvt_pk_bf16_f32 v33, v18, v19
    v_cvt_pk_bf16_f32 v34, v20, v21
    v_cvt_pk_bf16_f32 v35, v22, v23
    v_cvt_pk_bf16_f32 v36, v24, v25
    v_cvt_pk_bf16_f32 v37, v26, v27
    v_cvt_pk_bf16_f32 v38, v28, v29
    v_cvt_pk_bf16_f32 v39, v30, v31
    v_mov_b32 v12, v9
    s_lshl_b32 s44, s20, 11
    v_lshl_add_u32 v13, v1, 4, s44
    v_permlane32_swap_b32 v9, v12
    s_nop 0
    v_add_f32 v9, v9, v12
    ds_write_b128 v13, v[32:35] offset:0
    ds_write_b128 v13, v[36:39] offset:1024
    ds_write_b32 v10, v9 offset:8704
    s_mov_b64 exec, 1
    ds_add_u32 v224, v225 offset:9240
    s_mov_b64 exec, -1
k_main_kernel_spin22:
    ds_read_b32 v226, v224 offset:9240
    s_waitcnt lgkmcnt(0)
    v_readfirstlane_b32 s44, v226
    s_cmp_lt_u32 s44, 4
    s_cbranch_scc1 k_main_kernel_spin22
    ds_read_b128 v[32:35], v5 offset:0
    ds_read_b128 v[36:39], v5 offset:1024
    ds_read_b128 v[40:43], v5 offset:2048
    ds_read_b128 v[44:47], v5 offset:3072
    ds_read_b128 v[48:51], v5 offset:4096
    ds_read_b128 v[52:55], v5 offset:5120
    ds_read_b128 v[56:59], v5 offset:6144
    ds_read_b128 v[60:63], v5 offset:7168
    ds_read_b128 v[12:15], v11 offset:8704
    v_bfe_u32 v66, v1, 2, 2
    v_lshlrev_b32 v66, 2, v66
    v_lshl_add_u32 v66, v3, 1, v66
    v_mul_u32_u24 v66, 1040, v66
    v_bfe_u32 v67, v1, 4, 1
    v_lshlrev_b32 v67, 5, v67
    v_and_b32 v7, 3, v1
    v_lshl_add_u32 v67, v7, 3, v67
    s_lshl_b32 s45, s20, 8
    s_add_u32 s45, s45, 9296
    v_add3_u32 v64, v66, v67, s45
    v_add_u32 v65, 66560, v64
    ds_read_b64_tr_b16 v[160:161], v64 offset:0
    ds_read_b64_tr_b16 v[162:163], v64 offset:1040
    ds_read_b64_tr_b16 v[164:165], v64 offset:64
    ds_read_b64_tr_b16 v[166:167], v64 offset:1104
    ds_read_b64_tr_b16 v[168:169], v64 offset:128
    ds_read_b64_tr_b16 v[170:171], v64 offset:1168
    ds_read_b64_tr_b16 v[172:173], v64 offset:192
    ds_read_b64_tr_b16 v[174:175], v64 offset:1232
    ds_read_b64_tr_b16 v[192:193], v64 offset:16640
    ds_read_b64_tr_b16 v[194:195], v64 offset:17680
    ds_read_b64_tr_b16 v[196:197], v64 offset:16704
    ds_read_b64_tr_b16 v[198:199], v64 offset:17744
    ds_read_b64_tr_b16 v[200:201], v64 offset:16768
    ds_read_b64_tr_b16 v[202:203], v64 offset:17808
    ds_read_b64_tr_b16 v[204:205], v64 offset:16832
    ds_read_b64_tr_b16 v[206:207], v64 offset:17872
    s_waitcnt lgkmcnt(8)
    v_mfma_f32_32x32x16_bf16 v[96:111], v[160:163], v[32:35], 0
    v_mfma_f32_32x32x16_bf16 v[112:127], v[164:167], v[32:35], 0
    v_mfma_f32_32x32x16_bf16 v[128:143], v[168:171], v[32:35], 0
    v_mfma_f32_32x32x16_bf16 v[144:159], v[172:175], v[32:35], 0
    ds_read_b64_tr_b16 v[160:161], v64 offset:33280
    ds_read_b64_tr_b16 v[162:163], v64 offset:34320
    ds_read_b64_tr_b16 v[164:165], v64 offset:33344
    ds_read_b64_tr_b16 v[166:167], v64 offset:34384
    ds_read_b64_tr_b16 v[168:169], v64 offset:33408
    ds_read_b64_tr_b16 v[170:171], v64 offset:34448
    ds_read_b64_tr_b16 v[172:173], v64 offset:33472
    ds_read_b64_tr_b16 v[174:175], v64 offset:34512
    s_waitcnt lgkmcnt(8)
    v_mfma_f32_32x32x16_bf16 v[96:111], v[192:195], v[36:39], v[96:111]
    v_mfma_f32_32x32x16_bf16 v[112:127], v[196:199], v[36:39], v[112:127]
    v_mfma_f32_32x32x16_bf16 v[128:143], v[200:203], v[36:39], v[128:143]
    v_mfma_f32_32x32x16_bf16 v[144:159], v[204:207], v[36:39], v[144:159]
    ds_read_b64_tr_b16 v[192:193], v64 offset:49920
    ds_read_b64_tr_b16 v[194:195], v64 offset:50960
    ds_read_b64_tr_b16 v[196:197], v64 offset:49984
    ds_read_b64_tr_b16 v[198:199], v64 offset:51024
    ds_read_b64_tr_b16 v[200:201], v64 offset:50048
    ds_read_b64_tr_b16 v[202:203], v64 offset:51088
    ds_read_b64_tr_b16 v[204:205], v64 offset:50112
    ds_read_b64_tr_b16 v[206:207], v64 offset:51152
    s_waitcnt lgkmcnt(8)
    v_mfma_f32_32x32x16_bf16 v[96:111], v[160:163], v[40:43], v[96:111]
    v_mfma_f32_32x32x16_bf16 v[112:127], v[164:167], v[40:43], v[112:127]
    v_mfma_f32_32x32x16_bf16 v[128:143], v[168:171], v[40:43], v[128:143]
    v_mfma_f32_32x32x16_bf16 v[144:159], v[172:175], v[40:43], v[144:159]
    ds_read_b64_tr_b16 v[160:161], v65 offset:0
    ds_read_b64_tr_b16 v[162:163], v65 offset:1040
    ds_read_b64_tr_b16 v[164:165], v65 offset:64
    ds_read_b64_tr_b16 v[166:167], v65 offset:1104
    ds_read_b64_tr_b16 v[168:169], v65 offset:128
    ds_read_b64_tr_b16 v[170:171], v65 offset:1168
    ds_read_b64_tr_b16 v[172:173], v65 offset:192
    ds_read_b64_tr_b16 v[174:175], v65 offset:1232
    s_waitcnt lgkmcnt(8)
    v_mfma_f32_32x32x16_bf16 v[96:111], v[192:195], v[44:47], v[96:111]
    v_mfma_f32_32x32x16_bf16 v[112:127], v[196:199], v[44:47], v[112:127]
    v_mfma_f32_32x32x16_bf16 v[128:143], v[200:203], v[44:47], v[128:143]
    v_mfma_f32_32x32x16_bf16 v[144:159], v[204:207], v[44:47], v[144:159]
    ds_read_b64_tr_b16 v[192:193], v65 offset:16640
    ds_read_b64_tr_b16 v[194:195], v65 offset:17680
    ds_read_b64_tr_b16 v[196:197], v65 offset:16704
    ds_read_b64_tr_b16 v[198:199], v65 offset:17744
    ds_read_b64_tr_b16 v[200:201], v65 offset:16768
    ds_read_b64_tr_b16 v[202:203], v65 offset:17808
    ds_read_b64_tr_b16 v[204:205], v65 offset:16832
    ds_read_b64_tr_b16 v[206:207], v65 offset:17872
    s_waitcnt lgkmcnt(8)
    v_mfma_f32_32x32x16_bf16 v[96:111], v[160:163], v[48:51], v[96:111]
    v_mfma_f32_32x32x16_bf16 v[112:127], v[164:167], v[48:51], v[112:127]
    v_mfma_f32_32x32x16_bf16 v[128:143], v[168:171], v[48:51], v[128:143]
    v_mfma_f32_32x32x16_bf16 v[144:159], v[172:175], v[48:51], v[144:159]
    ds_read_b64_tr_b16 v[160:161], v65 offset:33280
    ds_read_b64_tr_b16 v[162:163], v65 offset:34320
    ds_read_b64_tr_b16 v[164:165], v65 offset:33344
    ds_read_b64_tr_b16 v[166:167], v65 offset:34384
    ds_read_b64_tr_b16 v[168:169], v65 offset:33408
    ds_read_b64_tr_b16 v[170:171], v65 offset:34448
    ds_read_b64_tr_b16 v[172:173], v65 offset:33472
    ds_read_b64_tr_b16 v[174:175], v65 offset:34512
    s_waitcnt lgkmcnt(8)
    v_mfma_f32_32x32x16_bf16 v[96:111], v[192:195], v[52:55], v[96:111]
    v_mfma_f32_32x32x16_bf16 v[112:127], v[196:199], v[52:55], v[112:127]
    v_mfma_f32_32x32x16_bf16 v[128:143], v[200:203], v[52:55], v[128:143]
    v_mfma_f32_32x32x16_bf16 v[144:159], v[204:207], v[52:55], v[144:159]
    ds_read_b64_tr_b16 v[192:193], v65 offset:49920
    ds_read_b64_tr_b16 v[194:195], v65 offset:50960
    ds_read_b64_tr_b16 v[196:197], v65 offset:49984
    ds_read_b64_tr_b16 v[198:199], v65 offset:51024
    ds_read_b64_tr_b16 v[200:201], v65 offset:50048
    ds_read_b64_tr_b16 v[202:203], v65 offset:51088
    ds_read_b64_tr_b16 v[204:205], v65 offset:50112
    ds_read_b64_tr_b16 v[206:207], v65 offset:51152
    s_waitcnt lgkmcnt(8)
    v_mfma_f32_32x32x16_bf16 v[96:111], v[160:163], v[56:59], v[96:111]
    v_mfma_f32_32x32x16_bf16 v[112:127], v[164:167], v[56:59], v[112:127]
    v_mfma_f32_32x32x16_bf16 v[128:143], v[168:171], v[56:59], v[128:143]
    v_mfma_f32_32x32x16_bf16 v[144:159], v[172:175], v[56:59], v[144:159]
    s_waitcnt lgkmcnt(0)
    v_mfma_f32_32x32x16_bf16 v[96:111], v[192:195], v[60:63], v[96:111]
    v_mfma_f32_32x32x16_bf16 v[112:127], v[196:199], v[60:63], v[112:127]
    v_mfma_f32_32x32x16_bf16 v[128:143], v[200:203], v[60:63], v[128:143]
    v_mfma_f32_32x32x16_bf16 v[144:159], v[204:207], v[60:63], v[144:159]
    v_add_f32 v12, v12, v13
    v_add_f32 v14, v14, v15
    v_add_f32 v9, v12, v14
    s_and_b32 s46, s2, 127
    s_lshl_b32 s47, s21, 12
    s_add_u32 s46, s46, s47
    s_lshl_b32 s46, s46, 3
    v_lshl_add_u32 v10, v2, 10, s46
    v_mov_b32 v228, v10
    s_lshl_b32 s46, s2, 15
    s_lshl_b32 s47, s20, 8
    s_add_u32 s46, s46, s47
    v_mul_u32_u24 v10, 1040, v2
    v_lshl_add_u32 v10, v3, 3, v10
    v_add_u32 v10, s45, v10
    v_lshrrev_b32 v11, 4, v1
    v_and_b32 v12, 15, v1
    v_mul_u32_u24 v13, 1040, v11
    v_lshl_add_u32 v13, v12, 4, v13
    v_add_u32 v13, s45, v13
    v_lshlrev_b32 v14, 10, v11
    v_lshl_add_u32 v14, v12, 4, v14
    v_cvt_pk_bf16_f32 v32, v96, v97
    v_cvt_pk_bf16_f32 v33, v98, v99
    ds_write_b64 v10, v[32:33] offset:0
    v_cvt_pk_bf16_f32 v34, v100, v101
    v_cvt_pk_bf16_f32 v35, v102, v103
    ds_write_b64 v10, v[34:35] offset:16
    v_cvt_pk_bf16_f32 v36, v104, v105
    v_cvt_pk_bf16_f32 v37, v106, v107
    ds_write_b64 v10, v[36:37] offset:32
    v_cvt_pk_bf16_f32 v38, v108, v109
    v_cvt_pk_bf16_f32 v39, v110, v111
    ds_write_b64 v10, v[38:39] offset:48
    v_cvt_pk_bf16_f32 v40, v112, v113
    v_cvt_pk_bf16_f32 v41, v114, v115
    ds_write_b64 v10, v[40:41] offset:64
    v_cvt_pk_bf16_f32 v42, v116, v117
    v_cvt_pk_bf16_f32 v43, v118, v119
    ds_write_b64 v10, v[42:43] offset:80
    v_cvt_pk_bf16_f32 v44, v120, v121
    v_cvt_pk_bf16_f32 v45, v122, v123
    ds_write_b64 v10, v[44:45] offset:96
    v_cvt_pk_bf16_f32 v46, v124, v125
    v_cvt_pk_bf16_f32 v47, v126, v127
    ds_write_b64 v10, v[46:47] offset:112
    v_cvt_pk_bf16_f32 v48, v128, v129
    v_cvt_pk_bf16_f32 v49, v130, v131
    ds_write_b64 v10, v[48:49] offset:128
    v_cvt_pk_bf16_f32 v50, v132, v133
    v_cvt_pk_bf16_f32 v51, v134, v135
    ds_write_b64 v10, v[50:51] offset:144
    v_cvt_pk_bf16_f32 v52, v136, v137
    v_cvt_pk_bf16_f32 v53, v138, v139
    ds_write_b64 v10, v[52:53] offset:160
    v_cvt_pk_bf16_f32 v54, v140, v141
    v_cvt_pk_bf16_f32 v55, v142, v143
    ds_write_b64 v10, v[54:55] offset:176
    v_cvt_pk_bf16_f32 v56, v144, v145
    v_cvt_pk_bf16_f32 v57, v146, v147
    ds_write_b64 v10, v[56:57] offset:192
    v_cvt_pk_bf16_f32 v58, v148, v149
    v_cvt_pk_bf16_f32 v59, v150, v151
    ds_write_b64 v10, v[58:59] offset:208
    v_cvt_pk_bf16_f32 v60, v152, v153
    v_cvt_pk_bf16_f32 v61, v154, v155
    ds_write_b64 v10, v[60:61] offset:224
    v_cvt_pk_bf16_f32 v62, v156, v157
    v_cvt_pk_bf16_f32 v63, v158, v159
    ds_write_b64 v10, v[62:63] offset:240
    ds_read_b128 v[160:163], v13 offset:0
    ds_read_b128 v[164:167], v13 offset:4160
    ds_read_b128 v[168:171], v13 offset:8320
    ds_read_b128 v[172:175], v13 offset:12480
    ds_read_b128 v[176:179], v13 offset:16640
    ds_read_b128 v[180:183], v13 offset:20800
    ds_read_b128 v[184:187], v13 offset:24960
    ds_read_b128 v[188:191], v13 offset:29120
    s_waitcnt lgkmcnt(7)
    buffer_store_dwordx4 v[160:163], v14, s[60:63], s46 offen sc1
    s_add_u32 s46, s46, 4096
    s_waitcnt lgkmcnt(6)
    buffer_store_dwordx4 v[164:167], v14, s[60:63], s46 offen sc1
    s_add_u32 s46, s46, 4096
    s_waitcnt lgkmcnt(5)
    buffer_store_dwordx4 v[168:171], v14, s[60:63], s46 offen sc1
    s_add_u32 s46, s46, 4096
    s_waitcnt lgkmcnt(4)
    buffer_store_dwordx4 v[172:175], v14, s[60:63], s46 offen sc1
    s_add_u32 s46, s46, 4096
    s_waitcnt lgkmcnt(3)
    buffer_store_dwordx4 v[176:179], v14, s[60:63], s46 offen sc1
    s_add_u32 s46, s46, 4096
    s_waitcnt lgkmcnt(2)
    buffer_store_dwordx4 v[180:183], v14, s[60:63], s46 offen sc1
    s_add_u32 s46, s46, 4096
    s_waitcnt lgkmcnt(1)
    buffer_store_dwordx4 v[184:187], v14, s[60:63], s46 offen sc1
    s_add_u32 s46, s46, 4096
    s_waitcnt lgkmcnt(0)
    buffer_store_dwordx4 v[188:191], v14, s[60:63], s46 offen sc1
    s_add_u32 s46, s46, 4096
    s_waitcnt vmcnt(0)
    v_mov_b32 v229, 0x7fc00000
    v_cmp_eq_u32 vcc, -1, v8
    s_nop 1
    v_cndmask_b32 v8, v8, v229, vcc
    v_cmp_eq_u32 vcc, -1, v9
    s_nop 1
    v_cndmask_b32 v9, v9, v229, vcc
    s_waitcnt vmcnt(0)
    s_mov_b64 exec, 1
    ds_add_rtn_u32 v226, v224, v225 offset:9244
    s_waitcnt lgkmcnt(0)
    v_readfirstlane_b32 s44, v226
    s_mov_b32 exec_lo, -1
    s_cmp_lg_u32 s44, 3
    s_cbranch_scc1 k_main_kernel_pubml24
    buffer_store_dwordx2 v[8:9], v228, s[64:67], 0 offen sc1
k_main_kernel_pubml24:
    s_mov_b64 exec, -1
    s_cmp_ge_u32 s2, 144
    s_cbranch_scc1 k_main_kernel_end
k_main_kernel_lw25:
    s_sleep 2
    ds_read_b32 v226, v224 offset:9256
    s_waitcnt lgkmcnt(0)
    v_readfirstlane_b32 s44, v226
    s_cmp_lt_u32 s44, 4
    s_cbranch_scc1 k_main_kernel_lw25
    v_lshrrev_b32 v10, 2, v1
    v_and_b32 v11, 3, v1
    v_bfe_u32 v9, v1, 5, 1
    v_lshlrev_b32 v9, 1, v9
    v_xor_b32 v11, v11, v9
    v_mul_u32_u24 v8, 9216, v10
    v_lshl_add_u32 v8, v11, 4, v8
    s_and_b32 s85, s2, 7
    s_lshl_b32 s85, s85, 1
    s_bfe_u32 s45, s2, 0x10003
    s_add_u32 s85, s85, s45
    s_andn2_b32 s45, s2, 15
    s_add_u32 s85, s85, s45
    s_mul_i32 s41, s20, 9*16*9216
    s_lshl_b32 s42, s85, 6
    s_add_u32 s41, s41, s42
    s_mul_i32 s43, s20, 9216
    s_add_u32 s43, s43, 63488
    s_add_u32 s44, s43, 36864
    s_mov_b32 m0, s43
    s_add_u32 s43, s43, 1024
    buffer_load_dwordx4 v8, s[72:75], s41 offen nt lds
    s_mov_b32 m0, s44
    s_add_u32 s44, s44, 1024
    buffer_load_dwordx4 v8, s[76:79], s41 offen nt lds
    s_add_u32 s41, s41, 147456
    s_mov_b32 m0, s43
    s_add_u32 s43, s43, 1024
    buffer_load_dwordx4 v8, s[72:75], s41 offen nt lds
    s_mov_b32 m0, s44
    s_add_u32 s44, s44, 1024
    buffer_load_dwordx4 v8, s[76:79], s41 offen nt lds
    s_add_u32 s41, s41, 147456
    s_mov_b32 m0, s43
    s_add_u32 s43, s43, 1024
    buffer_load_dwordx4 v8, s[72:75], s41 offen nt lds
    s_mov_b32 m0, s44
    s_add_u32 s44, s44, 1024
    buffer_load_dwordx4 v8, s[76:79], s41 offen nt lds
    s_add_u32 s41, s41, 147456
    s_waitcnt vmcnt(4)
    s_mov_b32 m0, s43
    s_add_u32 s43, s43, 1024
    buffer_load_dwordx4 v8, s[72:75], s41 offen nt lds
    s_mov_b32 m0, s44
    s_add_u32 s44, s44, 1024
    buffer_load_dwordx4 v8, s[76:79], s41 offen nt lds
    s_add_u32 s41, s41, 147456
    s_waitcnt vmcnt(4)
    s_mov_b32 m0, s43
    s_add_u32 s43, s43, 1024
    buffer_load_dwordx4 v8, s[72:75], s41 offen nt lds
    s_mov_b32 m0, s44
    s_add_u32 s44, s44, 1024
    buffer_load_dwordx4 v8, s[76:79], s41 offen nt lds
    s_add_u32 s41, s41, 147456
    s_waitcnt vmcnt(4)
    s_mov_b32 m0, s43
    s_add_u32 s43, s43, 1024
    buffer_load_dwordx4 v8, s[72:75], s41 offen nt lds
    s_mov_b32 m0, s44
    s_add_u32 s44, s44, 1024
    buffer_load_dwordx4 v8, s[76:79], s41 offen nt lds
    s_add_u32 s41, s41, 147456
    s_waitcnt vmcnt(4)
    s_mov_b32 m0, s43
    s_add_u32 s43, s43, 1024
    buffer_load_dwordx4 v8, s[72:75], s41 offen nt lds
    s_mov_b32 m0, s44
    s_add_u32 s44, s44, 1024
    buffer_load_dwordx4 v8, s[76:79], s41 offen nt lds
    s_add_u32 s41, s41, 147456
    s_waitcnt vmcnt(4)
    s_mov_b32 m0, s43
    s_add_u32 s43, s43, 1024
    buffer_load_dwordx4 v8, s[72:75], s41 offen nt lds
    s_mov_b32 m0, s44
    s_add_u32 s44, s44, 1024
    buffer_load_dwordx4 v8, s[76:79], s41 offen nt lds
    s_add_u32 s41, s41, 147456
    s_waitcnt vmcnt(4)
    s_mov_b32 m0, s43
    s_add_u32 s43, s43, 1024
    buffer_load_dwordx4 v8, s[72:75], s41 offen nt lds
    s_mov_b32 m0, s44
    s_add_u32 s44, s44, 1024
    buffer_load_dwordx4 v8, s[76:79], s41 offen nt lds
    s_add_u32 s41, s41, 147456
    s_waitcnt vmcnt(0)
    s_branch k_main_kernel_end
k_main_kernel_teamB1:
    v_subrev_u32 v0, 0x100, v0
    s_sub_u32 s20, s20, 4
    v_and_b32 v3, 15, v1
    v_lshrrev_b32 v4, 4, v1
    s_and_b32 s21, s2, 31
    s_lshr_b32 s22, s2, 5
    v_mov_b32 v124, 0
    v_mov_b32 v125, 1
    s_load_dwordx2 s[12:13], s[0:1], 32
    s_load_dwordx2 s[14:15], s[0:1], 40
    s_load_dwordx2 s[64:65], s[0:1], 72
    s_load_dwordx2 s[66:67], s[0:1], 0
    s_load_dwordx2 s[68:69], s[0:1], 80
    s_waitcnt lgkmcnt(0)
    s_mov_b32 s24, s12
    s_mov_b32 s25, s13
    s_mov_b32 s26, 4194304
    s_mov_b32 s27, 0x00020000
    s_add_u32 s28, s10, 1900544
    s_addc_u32 s29, s11, 0
    s_mov_b32 s30, 65536
    s_mov_b32 s31, 0x00020000
    s_add_u32 s32, s10, 2097152
    s_addc_u32 s33, s11, 0
    s_mov_b32 s34, 8388608
    s_mov_b32 s35, 0x00020000
    s_add_u32 s36, s10, 524288
    s_addc_u32 s37, s11, 0
    s_mov_b32 s38, 262144
    s_mov_b32 s39, 0x00020000
    s_add_u32 s56, s10, 1507328
    s_addc_u32 s57, s11, 0
    s_mov_b32 s58, 294912
    s_mov_b32 s59, 0x00020000
    s_add_u32 s60, s10, 786432
    s_addc_u32 s61, s11, 0
    s_mov_b32 s62, 663552
    s_mov_b32 s63, 0x00020000
    s_mov_b32 s72, s14
    s_mov_b32 s73, s15
    s_mov_b32 s74, 4718592
    s_mov_b32 s75, 0x00020000
    s_mov_b32 s76, s4
    s_mov_b32 s77, s5
    s_mov_b32 s78, 33554432
    s_mov_b32 s79, 0x00020000
    s_mov_b32 s84, s64
    s_mov_b32 s85, s65
    s_mov_b32 s86, 5308416
    s_mov_b32 s87, 0x00020000
    s_mov_b32 s88, s66
    s_mov_b32 s89, s67
    s_mov_b32 s90, 2304
    s_mov_b32 s91, 0x00020000
    s_mov_b32 s92, s68
    s_mov_b32 s93, s69
    s_mov_b32 s94, 2304
    s_mov_b32 s95, 0x00020000
    s_sub_u32 s47, s2, 144
    s_mul_i32 s48, s47, 7282
    s_lshr_b32 s48, s48, 16
    s_mul_i32 s49, s48, 9
    s_sub_u32 s49, s47, s49
    v_lshlrev_b32 v9, 4, v1
    s_lshl_b32 s40, s2, 7
    s_lshl_b32 s41, s20, 5
    s_add_u32 s40, s40, s41
    s_lshl_b32 s40, s40, 10
    s_mul_i32 s42, s41, 1040
    s_add_u32 s42, s42, 9296
    s_mov_b32 m0, s42
    s_add_u32 s42, s42, 1040
    buffer_load_dwordx4 v9, s[76:79], s40 offen nt lds
    s_add_u32 s40, s40, 1024
    s_mov_b32 m0, s42
    s_add_u32 s42, s42, 1040
    buffer_load_dwordx4 v9, s[76:79], s40 offen nt lds
    s_add_u32 s40, s40, 1024
    s_mov_b32 m0, s42
    s_add_u32 s42, s42, 1040
    buffer_load_dwordx4 v9, s[76:79], s40 offen nt lds
    s_add_u32 s40, s40, 1024
    s_waitcnt vmcnt(2)
    s_mov_b32 m0, s42
    s_add_u32 s42, s42, 1040
    buffer_load_dwordx4 v9, s[76:79], s40 offen nt lds
    s_add_u32 s40, s40, 1024
    s_waitcnt vmcnt(2)
    s_mov_b32 m0, s42
    s_add_u32 s42, s42, 1040
    buffer_load_dwordx4 v9, s[76:79], s40 offen nt lds
    s_add_u32 s40, s40, 1024
    s_waitcnt vmcnt(2)
    s_mov_b32 m0, s42
    s_add_u32 s42, s42, 1040
    buffer_load_dwordx4 v9, s[76:79], s40 offen nt lds
    s_add_u32 s40, s40, 1024
    s_waitcnt vmcnt(2)
    s_mov_b32 m0, s42
    s_add_u32 s42, s42, 1040
    buffer_load_dwordx4 v9, s[76:79], s40 offen nt lds
    s_add_u32 s40, s40, 1024
    s_waitcnt vmcnt(2)
    s_mov_b32 m0, s42
    s_add_u32 s42, s42, 1040
    buffer_load_dwordx4 v9, s[76:79], s40 offen nt lds
    s_add_u32 s40, s40, 1024
    s_waitcnt vmcnt(2)
    s_mov_b32 m0, s42
    s_add_u32 s42, s42, 1040
    buffer_load_dwordx4 v9, s[76:79], s40 offen nt lds
    s_add_u32 s40, s40, 1024
    s_waitcnt vmcnt(2)
    s_mov_b32 m0, s42
    s_add_u32 s42, s42, 1040
    buffer_load_dwordx4 v9, s[76:79], s40 offen nt lds
    s_add_u32 s40, s40, 1024
    s_waitcnt vmcnt(2)
    s_mov_b32 m0, s42
    s_add_u32 s42, s42, 1040
    buffer_load_dwordx4 v9, s[76:79], s40 offen nt lds
    s_add_u32 s40, s40, 1024
    s_waitcnt vmcnt(2)
    s_mov_b32 m0, s42
    s_add_u32 s42, s42, 1040
    buffer_load_dwordx4 v9, s[76:79], s40 offen nt lds
    s_add_u32 s40, s40, 1024
    s_waitcnt vmcnt(2)
    s_mov_b32 m0, s42
    s_add_u32 s42, s42, 1040
    buffer_load_dwordx4 v9, s[76:79], s40 offen nt lds
    s_add_u32 s40, s40, 1024
    s_waitcnt vmcnt(2)
    s_mov_b32 m0, s42
    s_add_u32 s42, s42, 1040
    buffer_load_dwordx4 v9, s[76:79], s40 offen nt lds
    s_add_u32 s40, s40, 1024
    s_waitcnt vmcnt(2)
    s_mov_b32 m0, s42
    s_add_u32 s42, s42, 1040
    buffer_load_dwordx4 v9, s[76:79], s40 offen nt lds
    s_add_u32 s40, s40, 1024
    s_waitcnt vmcnt(2)
    s_mov_b32 m0, s42
    s_add_u32 s42, s42, 1040
    buffer_load_dwordx4 v9, s[76:79], s40 offen nt lds
    s_add_u32 s40, s40, 1024
    s_waitcnt vmcnt(2)
    s_mov_b32 m0, s42
    s_add_u32 s42, s42, 1040
    buffer_load_dwordx4 v9, s[76:79], s40 offen nt lds
    s_add_u32 s40, s40, 1024
    s_waitcnt vmcnt(2)
    s_mov_b32 m0, s42
    s_add_u32 s42, s42, 1040
    buffer_load_dwordx4 v9, s[76:79], s40 offen nt lds
    s_add_u32 s40, s40, 1024
    s_waitcnt vmcnt(2)
    s_mov_b32 m0, s42
    s_add_u32 s42, s42, 1040
    buffer_load_dwordx4 v9, s[76:79], s40 offen nt lds
    s_add_u32 s40, s40, 1024
    s_waitcnt vmcnt(2)
    s_mov_b32 m0, s42
    s_add_u32 s42, s42, 1040
    buffer_load_dwordx4 v9, s[76:79], s40 offen nt lds
    s_add_u32 s40, s40, 1024
    s_waitcnt vmcnt(2)
    s_mov_b32 m0, s42
    s_add_u32 s42, s42, 1040
    buffer_load_dwordx4 v9, s[76:79], s40 offen nt lds
    s_add_u32 s40, s40, 1024
    s_waitcnt vmcnt(2)
    s_mov_b32 m0, s42
    s_add_u32 s42, s42, 1040
    buffer_load_dwordx4 v9, s[76:79], s40 offen nt lds
    s_add_u32 s40, s40, 1024
    s_waitcnt vmcnt(2)
    s_mov_b32 m0, s42
    s_add_u32 s42, s42, 1040
    buffer_load_dwordx4 v9, s[76:79], s40 offen nt lds
    s_add_u32 s40, s40, 1024
    s_waitcnt vmcnt(2)
    s_mov_b32 m0, s42
    s_add_u32 s42, s42, 1040
    buffer_load_dwordx4 v9, s[76:79], s40 offen nt lds
    s_add_u32 s40, s40, 1024
    s_waitcnt vmcnt(2)
    s_mov_b32 m0, s42
    s_add_u32 s42, s42, 1040
    buffer_load_dwordx4 v9, s[76:79], s40 offen nt lds
    s_add_u32 s40, s40, 1024
    s_waitcnt vmcnt(2)
    s_mov_b32 m0, s42
    s_add_u32 s42, s42, 1040
    buffer_load_dwordx4 v9, s[76:79], s40 offen nt lds
    s_add_u32 s40, s40, 1024
    s_waitcnt vmcnt(2)
    s_mov_b32 m0, s42
    s_add_u32 s42, s42, 1040
    buffer_load_dwordx4 v9, s[76:79], s40 offen nt lds
    s_add_u32 s40, s40, 1024
    s_waitcnt vmcnt(2)
    s_mov_b32 m0, s42
    s_add_u32 s42, s42, 1040
    buffer_load_dwordx4 v9, s[76:79], s40 offen nt lds
    s_add_u32 s40, s40, 1024
    s_waitcnt vmcnt(2)
    s_mov_b32 m0, s42
    s_add_u32 s42, s42, 1040
    buffer_load_dwordx4 v9, s[76:79], s40 offen nt lds
    s_add_u32 s40, s40, 1024
    s_waitcnt vmcnt(2)
    s_mov_b32 m0, s42
    s_add_u32 s42, s42, 1040
    buffer_load_dwordx4 v9, s[76:79], s40 offen nt lds
    s_add_u32 s40, s40, 1024
    s_waitcnt vmcnt(2)
    s_mov_b32 m0, s42
    s_add_u32 s42, s42, 1040
    buffer_load_dwordx4 v9, s[76:79], s40 offen nt lds
    s_add_u32 s40, s40, 1024
    s_waitcnt vmcnt(2)
    s_mov_b32 m0, s42
    s_add_u32 s42, s42, 1040
    buffer_load_dwordx4 v9, s[76:79], s40 offen nt lds
    s_add_u32 s40, s40, 1024
    v_lshlrev_b32 v13, 1, v4
    v_xor_b32 v13, v13, v3
    v_lshlrev_b32 v13, 4, v13
    v_lshl_add_u32 v13, v4, 13, v13
    v_xor_b32 v14, 0x80, v13
    s_lshl_b32 s44, s22, 6
    s_lshl_b32 s45, s20, 4
    s_add_u32 s44, s44, s45
    s_lshl_b32 s44, s44, 13
    s_lshl_b32 s45, s21, 8
    s_add_u32 s44, s44, s45
    s_waitcnt vmcnt(0)
    s_mov_b64 exec, 1
    ds_add_u32 v124, v125 offset:9216
    s_mov_b64 exec, -1
    buffer_load_dwordx4 v[128:131], v13, s[24:27], s44 offen nt
    s_add_u32 s44, s44, 32768
    buffer_load_dwordx4 v[132:135], v13, s[24:27], s44 offen nt
    s_add_u32 s44, s44, 32768
    buffer_load_dwordx4 v[136:139], v14, s[24:27], s44 offen nt
    s_add_u32 s44, s44, 32768
    buffer_load_dwordx4 v[140:143], v14, s[24:27], s44 offen nt
    s_add_u32 s44, s44, 32768
    s_cmp_lt_u32 s2, 144
    s_cbranch_scc1 k_main_kernel_ldW26
    s_cmp_ge_u32 s2, 216
    s_cbranch_scc1 k_main_kernel_ldW26
    v_lshrrev_b32 v10, 3, v1
    v_and_b32 v11, 7, v1
    v_and_b32 v12, 2, v10
    v_xor_b32 v11, v11, v12
    v_mul_u32_u24 v8, 1152, v10
    v_lshl_add_u32 v8, v11, 4, v8
    v_xor_b32 v11, 4, v11
    v_mul_u32_u24 v7, 1152, v10
    v_lshl_add_u32 v7, v11, 4, v7
    s_lshl_b32 s41, s48, 9
    s_lshl_b32 s42, s20, 7
    s_add_u32 s41, s41, s42
    s_mul_i32 s41, s41, 1152
    s_lshl_b32 s42, s49, 7
    s_add_u32 s41, s41, s42
    buffer_load_dwordx4 v[144:147], v8, s[72:75], s41 offen nt
    s_add_u32 s41, s41, 9216
    buffer_load_dwordx4 v[148:151], v7, s[72:75], s41 offen nt
    s_add_u32 s41, s41, 9216
    buffer_load_dwordx4 v[152:155], v8, s[72:75], s41 offen nt
    s_add_u32 s41, s41, 9216
    buffer_load_dwordx4 v[156:159], v7, s[72:75], s41 offen nt
    s_add_u32 s41, s41, 9216
    buffer_load_dwordx4 v[160:163], v8, s[72:75], s41 offen nt
    s_add_u32 s41, s41, 9216
    buffer_load_dwordx4 v[164:167], v7, s[72:75], s41 offen nt
    s_add_u32 s41, s41, 9216
    buffer_load_dwordx4 v[168:171], v8, s[72:75], s41 offen nt
    s_add_u32 s41, s41, 9216
    buffer_load_dwordx4 v[172:175], v7, s[72:75], s41 offen nt
    s_add_u32 s41, s41, 9216
    buffer_load_dwordx4 v[176:179], v8, s[72:75], s41 offen nt
    s_add_u32 s41, s41, 9216
    buffer_load_dwordx4 v[180:183], v7, s[72:75], s41 offen nt
    s_add_u32 s41, s41, 9216
    buffer_load_dwordx4 v[184:187], v8, s[72:75], s41 offen nt
    s_add_u32 s41, s41, 9216
    buffer_load_dwordx4 v[188:191], v7, s[72:75], s41 offen nt
    s_add_u32 s41, s41, 9216
    buffer_load_dwordx4 v[192:195], v8, s[72:75], s41 offen nt
    s_add_u32 s41, s41, 9216
    buffer_load_dwordx4 v[196:199], v7, s[72:75], s41 offen nt
    s_add_u32 s41, s41, 9216
    buffer_load_dwordx4 v[200:203], v8, s[72:75], s41 offen nt
    s_add_u32 s41, s41, 9216
    buffer_load_dwordx4 v[204:207], v7, s[72:75], s41 offen nt
    s_add_u32 s41, s41, 9216
k_main_kernel_ldW26:
k_main_kernel_lw27:
    s_sleep 2
    ds_read_b32 v126, v124 offset:9244
    s_waitcnt lgkmcnt(0)
    v_readfirstlane_b32 s46, v126
    s_cmp_lt_u32 s46, 4
    s_cbranch_scc1 k_main_kernel_lw27
    s_waitcnt vmcnt(0)
    s_lshl_b32 s41, s20, 12
    s_add_u32 s41, s41, 9728
    v_add_u32 v10, s41, v9
    ds_write_b128 v10, v[128:131] offset:0
    ds_write_b128 v10, v[132:135] offset:1024
    ds_write_b128 v10, v[136:139] offset:2048
    ds_write_b128 v10, v[140:143] offset:3072
    s_cmp_lt_u32 s2, 144
    s_cbranch_scc1 k_main_kernel_stW28
    s_cmp_ge_u32 s2, 216
    s_cbranch_scc1 k_main_kernel_stW28
    s_lshl_b32 s41, s20, 14
    s_add_u32 s41, s41, 63488
    v_add_u32 v10, s41, v9
    ds_write_b128 v10, v[144:147] offset:0
    ds_write_b128 v10, v[148:151] offset:1024
    ds_write_b128 v10, v[152:155] offset:2048
    ds_write_b128 v10, v[156:159] offset:3072
    ds_write_b128 v10, v[160:163] offset:4096
    ds_write_b128 v10, v[164:167] offset:5120
    ds_write_b128 v10, v[168:171] offset:6144
    ds_write_b128 v10, v[172:175] offset:7168
    ds_write_b128 v10, v[176:179] offset:8192
    ds_write_b128 v10, v[180:183] offset:9216
    ds_write_b128 v10, v[184:187] offset:10240
    ds_write_b128 v10, v[188:191] offset:11264
    ds_write_b128 v10, v[192:195] offset:12288
    ds_write_b128 v10, v[196:199] offset:13312
    ds_write_b128 v10, v[200:203] offset:14336
    ds_write_b128 v10, v[204:207] offset:15360
k_main_kernel_stW28:
    v_lshrrev_b32 v5, 7, v0
    v_and_b32 v6, 127, v0
    v_lshlrev_b32 v5, 12, v5
    v_add_u32 v5, v5, v6
    s_lshl_b32 s40, s21, 7
    v_add_u32 v5, s40, v5
    v_lshlrev_b32 v5, 3, v5
    s_mov_b32 s46, 0
k_main_kernel_poll29:
    buffer_load_dwordx2 v[8:9], v5, s[28:31], 0 offen sc1
    s_waitcnt vmcnt(0)
    v_max_u32 v7, v8, v9
    v_cmp_eq_u32 vcc, -1, v7
    s_add_u32 s46, s46, 1
    s_cmp_gt_u32 s46, 40000
    s_cbranch_scc1 k_main_kernel_pdone30
    s_cbranch_vccz k_main_kernel_pdone30
    s_sleep 1
    s_branch k_main_kernel_poll29
k_main_kernel_pdone30:
    v_lshrrev_b32 v10, 3, v1
    v_and_b32 v11, 7, v1
    v_and_b32 v12, 2, v10
    v_xor_b32 v11, v11, v12
    v_lshlrev_b32 v11, 4, v11
    v_lshl_add_u32 v11, v10, 15, v11
    v_xor_b32 v12, 64, v11
    s_lshl_b32 s41, s21, 10
    s_lshl_b32 s42, s22, 7
    s_add_u32 s41, s41, s42
    s_lshl_b32 s42, s20, 21
    s_add_u32 s41, s41, s42
    s_lshl_b32 s43, s20, 13
    s_add_u32 s43, s43, 26112
    s_mov_b32 m0, s43
    s_add_u32 s43, s43, 1024
    buffer_load_dwordx4 v11, s[32:35], s41 offen sc1 lds
    s_add_u32 s41, s41, 262144
    s_mov_b32 m0, s43
    s_add_u32 s43, s43, 1024
    buffer_load_dwordx4 v12, s[32:35], s41 offen sc1 lds
    s_add_u32 s41, s41, 262144
    s_mov_b32 m0, s43
    s_add_u32 s43, s43, 1024
    buffer_load_dwordx4 v11, s[32:35], s41 offen sc1 lds
    s_add_u32 s41, s41, 262144
    s_mov_b32 m0, s43
    s_add_u32 s43, s43, 1024
    buffer_load_dwordx4 v12, s[32:35], s41 offen sc1 lds
    s_add_u32 s41, s41, 262144
    s_mov_b32 m0, s43
    s_add_u32 s43, s43, 1024
    buffer_load_dwordx4 v11, s[32:35], s41 offen sc1 lds
    s_add_u32 s41, s41, 262144
    s_mov_b32 m0, s43
    s_add_u32 s43, s43, 1024
    buffer_load_dwordx4 v12, s[32:35], s41 offen sc1 lds
    s_add_u32 s41, s41, 262144
    s_mov_b32 m0, s43
    s_add_u32 s43, s43, 1024
    buffer_load_dwordx4 v11, s[32:35], s41 offen sc1 lds
    s_add_u32 s41, s41, 262144
    s_mov_b32 m0, s43
    s_add_u32 s43, s43, 1024
    buffer_load_dwordx4 v12, s[32:35], s41 offen sc1 lds
    s_add_u32 s41, s41, 262144
    v_mov_b32 v15, v8
    s_nop 1
    v_max_f32_dpp v15, v15, v15 quad_perm:[1,0,3,2] row_mask:0xf bank_mask:0xf
    s_nop 1
    v_max_f32_dpp v15, v15, v15 quad_perm:[2,3,0,1] row_mask:0xf bank_mask:0xf
    s_nop 1
    v_max_f32_dpp v15, v15, v15 row_half_mirror row_mask:0xf bank_mask:0xf
    s_nop 1
    v_max_f32_dpp v15, v15, v15 row_mirror row_mask:0xf bank_mask:0xf
    v_mov_b32 v16, v15
    s_nop 1
    v_permlane16_swap_b32 v15, v16
    s_nop 0
    v_max_f32 v15, v15, v16
    v_mov_b32 v16, v15
    s_nop 1
    v_permlane32_swap_b32 v15, v16
    s_nop 0
    v_max_f32 v15, v15, v16
    s_lshl_b32 s46, s20, 2
    v_mov_b32 v17, s46
    ds_write_b32 v17, v15 offset:2048
    s_waitcnt lgkmcnt(0)
    s_mov_b64 exec, 1
    ds_add_u32 v124, v125 offset:9248
    s_mov_b64 exec, -1
k_main_kernel_spin31:
    ds_read_b32 v126, v124 offset:9248
    s_waitcnt lgkmcnt(0)
    v_readfirstlane_b32 s46, v126
    s_cmp_lt_u32 s46, 4
    s_cbranch_scc1 k_main_kernel_spin31
    s_and_b32 s47, s20, 2
    s_lshl_b32 s47, s47, 2
    v_mov_b32 v18, s47
    ds_read_b64 v[20:21], v18 offset:2048
    s_waitcnt lgkmcnt(0)
    v_max_f32 v15, v20, v21
    v_sub_f32 v8, v8, v15
    v_exp_f32 v8, v8
    s_nop 0
    v_mul_f32 v19, v8, v9
    s_nop 1
    v_add_f32_dpp v19, v19, v19 quad_perm:[1,0,3,2] row_mask:0xf bank_mask:0xf
    s_nop 1
    v_add_f32_dpp v19, v19, v19 quad_perm:[2,3,0,1] row_mask:0xf bank_mask:0xf
    s_nop 1
    v_add_f32_dpp v19, v19, v19 row_half_mirror row_mask:0xf bank_mask:0xf
    s_nop 1
    v_add_f32_dpp v19, v19, v19 row_mirror row_mask:0xf bank_mask:0xf
    v_mov_b32 v16, v19
    s_nop 1
    v_permlane16_swap_b32 v19, v16
    s_nop 0
    v_add_f32 v19, v19, v16
    v_mov_b32 v16, v19
    s_nop 1
    v_permlane32_swap_b32 v19, v16
    s_nop 0
    v_add_f32 v19, v19, v16
    ds_write_b32 v17, v19 offset:2064
    s_waitcnt lgkmcnt(0)
    s_mov_b64 exec, 1
    ds_add_u32 v124, v125 offset:9252
    s_mov_b64 exec, -1
k_main_kernel_spin32:
    ds_read_b32 v126, v124 offset:9252
    s_waitcnt lgkmcnt(0)
    v_readfirstlane_b32 s46, v126
    s_cmp_lt_u32 s46, 4
    s_cbranch_scc1 k_main_kernel_spin32
    ds_read_b64 v[20:21], v18 offset:2064
    s_waitcnt lgkmcnt(0)
    v_add_f32 v19, v20, v21
    v_rcp_f32 v19, v19
    s_nop 0
    v_mul_f32 v8, v8, v19
    v_cvt_pk_bf16_f32 v22, v8, v8
    v_lshlrev_b32 v24, 16, v22
    v_sub_f32 v24, v8, v24
    v_cvt_pk_bf16_f32 v23, v24, v24
    v_lshrrev_b32 v25, 7, v0
    v_lshlrev_b32 v25, 9, v25
    v_lshl_add_u32 v25, v6, 1, v25
    ds_write_b16 v25, v22 offset:0
    ds_write_b16 v25, v23 offset:256
    s_waitcnt vmcnt(0) lgkmcnt(0)
    s_mov_b64 exec, 1
    ds_add_u32 v124, v125 offset:9256
    s_mov_b64 exec, -1
k_main_kernel_spin33:
    ds_read_b32 v126, v124 offset:9256
    s_waitcnt lgkmcnt(0)
    v_readfirstlane_b32 s46, v126
    s_cmp_lt_u32 s46, 4
    s_cbranch_scc1 k_main_kernel_spin33
    v_and_b32 v26, 1, v1
    v_lshlrev_b32 v26, 8, v26
    v_lshl_add_u32 v26, v4, 4, v26
    s_lshr_b32 s46, s20, 1
    s_lshl_b32 s47, s46, 9
    v_add_u32 v26, s47, v26
    ds_read_b128 v[28:31], v26 offset:0
    ds_read_b128 v[32:35], v26 offset:64
    ds_read_b128 v[36:39], v26 offset:128
    ds_read_b128 v[40:43], v26 offset:192
    v_lshrrev_b32 v9, 2, v3
    v_lshl_add_u32 v10, v4, 3, v9
    v_lshlrev_b32 v10, 7, v10
    v_and_b32 v11, 2, v9
    v_and_b32 v12, 1, v4
    v_lshl_or_b32 v11, v12, 2, v11
    v_bfe_u32 v12, v3, 1, 1
    s_and_b32 s47, s20, 1
    s_lshl_b32 s47, s47, 2
    v_add_u32 v12, s47, v12
    v_and_b32 v13, 1, v3
    v_lshl_add_u32 v10, v13, 3, v10
    s_lshl_b32 s47, s46, 14
    s_add_u32 s47, s47, 26112
    v_add_u32 v10, s47, v10
    v_add_u32 v14, 0, v12
    v_xor_b32 v14, v14, v11
    v_lshl_add_u32 v15, v14, 4, v10
    v_add_u32 v14, 2, v12
    v_xor_b32 v14, v14, v11
    v_lshl_add_u32 v16, v14, 4, v10
    ds_read_b64_tr_b16 v[44:45], v15 offset:0
    ds_read_b64_tr_b16 v[46:47], v15 offset:512
    ds_read_b64_tr_b16 v[48:49], v15 offset:4096
    ds_read_b64_tr_b16 v[50:51], v15 offset:4608
    ds_read_b64_tr_b16 v[52:53], v15 offset:8192
    ds_read_b64_tr_b16 v[54:55], v15 offset:8704
    ds_read_b64_tr_b16 v[56:57], v15 offset:12288
    ds_read_b64_tr_b16 v[58:59], v15 offset:12800
    ds_read_b64_tr_b16 v[60:61], v16 offset:0
    ds_read_b64_tr_b16 v[62:63], v16 offset:512
    ds_read_b64_tr_b16 v[64:65], v16 offset:4096
    ds_read_b64_tr_b16 v[66:67], v16 offset:4608
    ds_read_b64_tr_b16 v[68:69], v16 offset:8192
    ds_read_b64_tr_b16 v[70:71], v16 offset:8704
    ds_read_b64_tr_b16 v[72:73], v16 offset:12288
    ds_read_b64_tr_b16 v[74:75], v16 offset:12800
    s_waitcnt lgkmcnt(0)
    v_mfma_f32_16x16x32_bf16 v[20:23], v[28:31], v[44:47], 0
    v_mfma_f32_16x16x32_bf16 v[20:23], v[32:35], v[48:51], v[20:23]
    v_mfma_f32_16x16x32_bf16 v[20:23], v[36:39], v[52:55], v[20:23]
    v_mfma_f32_16x16x32_bf16 v[20:23], v[40:43], v[56:59], v[20:23]
    v_mfma_f32_16x16x32_bf16 v[76:79], v[28:31], v[60:63], 0
    v_mfma_f32_16x16x32_bf16 v[76:79], v[32:35], v[64:67], v[76:79]
    v_mfma_f32_16x16x32_bf16 v[76:79], v[36:39], v[68:71], v[76:79]
    v_mfma_f32_16x16x32_bf16 v[76:79], v[40:43], v[72:75], v[76:79]
    s_and_b32 s47, s20, 1
    s_lshl_b32 s47, s47, 6
    s_lshl_b32 s50, s46, 7
    s_add_u32 s47, s47, s50
    v_lshl_add_u32 v27, v3, 1, s47
    s_nop 7
    v_add_f32 v8, v20, v21
    v_cvt_pk_bf16_f32 v9, v8, v8
    v_lshlrev_b32 v25, 16, v9
    v_sub_f32 v25, v8, v25
    v_cvt_pk_bf16_f32 v24, v25, v25
    ds_write_b16 v27, v9 offset:1024
    ds_write_b16 v27, v24 offset:1280
    v_add_f32 v8, v76, v77
    v_cvt_pk_bf16_f32 v9, v8, v8
    v_lshlrev_b32 v25, 16, v9
    v_sub_f32 v25, v8, v25
    v_cvt_pk_bf16_f32 v24, v25, v25
    ds_write_b16 v27, v9 offset:1056
    ds_write_b16 v27, v24 offset:1312
    s_waitcnt lgkmcnt(0)
    s_mov_b64 exec, 1
    ds_add_u32 v124, v125 offset:9260
    s_mov_b64 exec, -1
k_main_kernel_spin34:
    ds_read_b32 v126, v124 offset:9260
    s_waitcnt lgkmcnt(0)
    v_readfirstlane_b32 s46, v126
    s_cmp_lt_u32 s46, 4
    s_cbranch_scc1 k_main_kernel_spin34
    v_and_b32 v8, 3, v1
    v_lshlrev_b32 v8, 7, v8
    v_lshl_add_u32 v8, v4, 4, v8
    ds_read_b128 v[28:31], v8 offset:1024
    ds_read_b128 v[32:35], v8 offset:1088
    v_lshrrev_b32 v9, 2, v3
    v_lshl_add_u32 v10, v4, 3, v9
    v_lshlrev_b32 v10, 8, v10
    v_and_b32 v11, 1, v4
    v_lshlrev_b32 v11, 3, v11
    v_lshl_or_b32 v11, v9, 1, v11
    v_bfe_u32 v12, v3, 1, 1
    s_lshl_b32 s47, s20, 2
    v_add_u32 v12, s47, v12
    v_and_b32 v13, 1, v3
    v_lshl_add_u32 v10, v13, 3, v10
    v_add_u32 v14, 0, v12
    v_xor_b32 v14, v14, v11
    v_lshl_add_u32 v15, v14, 4, v10
    v_add_u32 v14, 2, v12
    v_xor_b32 v14, v14, v11
    v_lshl_add_u32 v16, v14, 4, v10
    ds_read_b64_tr_b16 v[44:45], v15 offset:9728
    ds_read_b64_tr_b16 v[46:47], v15 offset:10752
    ds_read_b64_tr_b16 v[48:49], v15 offset:17920
    ds_read_b64_tr_b16 v[50:51], v15 offset:18944
    ds_read_b64_tr_b16 v[52:53], v16 offset:9728
    ds_read_b64_tr_b16 v[54:55], v16 offset:10752
    ds_read_b64_tr_b16 v[56:57], v16 offset:17920
    ds_read_b64_tr_b16 v[58:59], v16 offset:18944
    s_waitcnt lgkmcnt(0)
    v_mfma_f32_16x16x32_bf16 v[20:23], v[28:31], v[44:47], 0
    v_mfma_f32_16x16x32_bf16 v[20:23], v[32:35], v[48:51], v[20:23]
    v_mfma_f32_16x16x32_bf16 v[76:79], v[28:31], v[52:55], 0
    v_mfma_f32_16x16x32_bf16 v[76:79], v[32:35], v[56:59], v[76:79]
    s_lshl_b32 s47, s22, 15
    s_lshl_b32 s50, s21, 9
    s_add_u32 s47, s47, s50
    s_lshl_b32 s50, s20, 7
    s_add_u32 s47, s47, s50
    v_lshl_add_u32 v27, v3, 2, s47
    s_nop 7
    v_add_f32 v8, v20, v22
    v_add_f32 v9, v21, v23
    v_add_f32 v10, v76, v78
    v_add_f32 v11, v77, v79
    v_mov_b32 v12, 0x7fc00000
    v_cmp_eq_u32 vcc, -1, v8
    s_nop 1
    v_cndmask_b32 v8, v8, v12, vcc
    v_cmp_eq_u32 vcc, -1, v9
    s_nop 1
    v_cndmask_b32 v9, v9, v12, vcc
    v_cmp_eq_u32 vcc, -1, v10
    s_nop 1
    v_cndmask_b32 v10, v10, v12, vcc
    v_cmp_eq_u32 vcc, -1, v11
    s_nop 1
    v_cndmask_b32 v11, v11, v12, vcc
    s_mov_b32 s47, 16384
    v_cmp_gt_u32 vcc, 16, v1
    s_and_saveexec_b64 s[50:51], vcc
    buffer_store_dword v8, v27, s[36:39], 0 offen sc1
    buffer_store_dword v9, v27, s[36:39], s47 offen sc1
    buffer_store_dword v10, v27, s[36:39], 0 offen offset:64 sc1
    buffer_store_dword v11, v27, s[36:39], s47 offen offset:64 sc1
    s_mov_b64 exec, s[50:51]
    s_cmp_ge_u32 s2, 144
    s_cbranch_scc1 k_main_kernel_phE35
    s_barrier
    s_and_b32 s83, s2, 7
    s_lshl_b32 s83, s83, 1
    s_bfe_u32 s45, s2, 0x10003
    s_add_u32 s83, s83, s45
    s_andn2_b32 s45, s2, 15
    s_add_u32 s83, s83, s45
    v_lshlrev_b32 v9, 4, v1
    s_mul_i32 s41, s83, 36864
    s_mul_i32 s42, s20, 9216
    s_add_u32 s41, s41, s42
    s_add_u32 s43, s42, 26112
    s_mov_b32 m0, s43
    s_add_u32 s43, s43, 1024
    buffer_load_dwordx4 v9, s[84:87], s41 offen nt lds
    s_add_u32 s41, s41, 1024
    s_mov_b32 m0, s43
    s_add_u32 s43, s43, 1024
    buffer_load_dwordx4 v9, s[84:87], s41 offen nt lds
    s_add_u32 s41, s41, 1024
    s_mov_b32 m0, s43
    s_add_u32 s43, s43, 1024
    buffer_load_dwordx4 v9, s[84:87], s41 offen nt lds
    s_add_u32 s41, s41, 1024
    s_mov_b32 m0, s43
    s_add_u32 s43, s43, 1024
    buffer_load_dwordx4 v9, s[84:87], s41 offen nt lds
    s_add_u32 s41, s41, 1024
    s_mov_b32 m0, s43
    s_add_u32 s43, s43, 1024
    buffer_load_dwordx4 v9, s[84:87], s41 offen nt lds
    s_add_u32 s41, s41, 1024
    s_mov_b32 m0, s43
    s_add_u32 s43, s43, 1024
    buffer_load_dwordx4 v9, s[84:87], s41 offen nt lds
    s_add_u32 s41, s41, 1024
    s_mov_b32 m0, s43
    s_add_u32 s43, s43, 1024
    buffer_load_dwordx4 v9, s[84:87], s41 offen nt lds
    s_add_u32 s41, s41, 1024
    s_mov_b32 m0, s43
    s_add_u32 s43, s43, 1024
    buffer_load_dwordx4 v9, s[84:87], s41 offen nt lds
    s_add_u32 s41, s41, 1024
    s_mov_b32 m0, s43
    s_add_u32 s43, s43, 1024
    buffer_load_dwordx4 v9, s[84:87], s41 offen nt lds
    s_add_u32 s41, s41, 1024
    v_lshlrev_b32 v5, 4, v0
    v_mov_b32 v6, 0x7fffffff
    v_cmp_gt_u32 vcc, 144, v0
    s_nop 1
    v_cndmask_b32 v5, v6, v5, vcc
    v_lshrrev_b32 v8, 1, v5
    v_cndmask_b32 v8, v6, v8, vcc
    s_mov_b64 s[64:65], vcc
    buffer_load_dwordx2 v[84:85], v8, s[88:91], 0 offen
    buffer_load_dwordx2 v[86:87], v8, s[88:91], 0 offen offset:1152
    s_and_b32 s41, s2, 7
    s_mul_i32 s41, s41, 36864
    s_mov_b32 s46, 0
k_main_kernel_pre39:
    s_add_u32 s40, s41, 32256
    buffer_load_dwordx4 v[80:83], v5, s[56:59], s40 offen offset:2304 sc1
    s_waitcnt vmcnt(0)
    v_max_u32 v7, v80, v81
    v_max3_u32 v7, v7, v82, v83
    v_cmp_eq_u32 vcc, -1, v7
    s_add_u32 s46, s46, 1
    s_cmp_gt_u32 s46, 40000
    s_cbranch_scc1 k_main_kernel_pred40
    s_cbranch_vccz k_main_kernel_pred40
    s_sleep 4
    s_branch k_main_kernel_pre39
k_main_kernel_pred40:
k_main_kernel_poll37:
    s_add_u32 s40, s41, 0
    buffer_load_dwordx4 v[20:23], v5, s[56:59], s40 offen offset:0 sc1
    s_add_u32 s40, s41, 0
    buffer_load_dwordx4 v[24:27], v5, s[56:59], s40 offen offset:2304 sc1
    s_add_u32 s40, s41, 4608
    buffer_load_dwordx4 v[28:31], v5, s[56:59], s40 offen offset:0 sc1
    s_add_u32 s40, s41, 4608
    buffer_load_dwordx4 v[32:35], v5, s[56:59], s40 offen offset:2304 sc1
    s_add_u32 s40, s41, 9216
    buffer_load_dwordx4 v[36:39], v5, s[56:59], s40 offen offset:0 sc1
    s_add_u32 s40, s41, 9216
    buffer_load_dwordx4 v[40:43], v5, s[56:59], s40 offen offset:2304 sc1
    s_add_u32 s40, s41, 13824
    buffer_load_dwordx4 v[44:47], v5, s[56:59], s40 offen offset:0 sc1
    s_add_u32 s40, s41, 13824
    buffer_load_dwordx4 v[48:51], v5, s[56:59], s40 offen offset:2304 sc1
    s_add_u32 s40, s41, 18432
    buffer_load_dwordx4 v[52:55], v5, s[56:59], s40 offen offset:0 sc1
    s_add_u32 s40, s41, 18432
    buffer_load_dwordx4 v[56:59], v5, s[56:59], s40 offen offset:2304 sc1
    s_add_u32 s40, s41, 23040
    buffer_load_dwordx4 v[60:63], v5, s[56:59], s40 offen offset:0 sc1
    s_add_u32 s40, s41, 23040
    buffer_load_dwordx4 v[64:67], v5, s[56:59], s40 offen offset:2304 sc1
    s_add_u32 s40, s41, 27648
    buffer_load_dwordx4 v[68:71], v5, s[56:59], s40 offen offset:0 sc1
    s_add_u32 s40, s41, 27648
    buffer_load_dwordx4 v[72:75], v5, s[56:59], s40 offen offset:2304 sc1
    s_add_u32 s40, s41, 32256
    buffer_load_dwordx4 v[76:79], v5, s[56:59], s40 offen offset:0 sc1
    s_add_u32 s40, s41, 32256
    buffer_load_dwordx4 v[80:83], v5, s[56:59], s40 offen offset:2304 sc1
    s_waitcnt vmcnt(0)
    v_max_u32 v7, v20, v21
    v_max3_u32 v7, v7, v22, v23
    v_max3_u32 v7, v7, v24, v25
    v_max3_u32 v7, v7, v26, v27
    v_max3_u32 v7, v7, v28, v29
    v_max3_u32 v7, v7, v30, v31
    v_max3_u32 v7, v7, v32, v33
    v_max3_u32 v7, v7, v34, v35
    v_max3_u32 v7, v7, v36, v37
    v_max3_u32 v7, v7, v38, v39
    v_max3_u32 v7, v7, v40, v41
    v_max3_u32 v7, v7, v42, v43
    v_max3_u32 v7, v7, v44, v45
    v_max3_u32 v7, v7, v46, v47
    v_max3_u32 v7, v7, v48, v49
    v_max3_u32 v7, v7, v50, v51
    v_max3_u32 v7, v7, v52, v53
    v_max3_u32 v7, v7, v54, v55
    v_max3_u32 v7, v7, v56, v57
    v_max3_u32 v7, v7, v58, v59
    v_max3_u32 v7, v7, v60, v61
    v_max3_u32 v7, v7, v62, v63
    v_max3_u32 v7, v7, v64, v65
    v_max3_u32 v7, v7, v66, v67
    v_max3_u32 v7, v7, v68, v69
    v_max3_u32 v7, v7, v70, v71
    v_max3_u32 v7, v7, v72, v73
    v_max3_u32 v7, v7, v74, v75
    v_max3_u32 v7, v7, v76, v77
    v_max3_u32 v7, v7, v78, v79
    v_max3_u32 v7, v7, v80, v81
    v_max3_u32 v7, v7, v82, v83
    v_cmp_eq_u32 vcc, -1, v7
    s_add_u32 s46, s46, 1
    s_cmp_gt_u32 s46, 40000
    s_cbranch_scc1 k_main_kernel_pdone38
    s_cbranch_vccz k_main_kernel_pdone38
    s_sleep 1
    s_branch k_main_kernel_poll37
k_main_kernel_pdone38:
    v_add_f32 v20, v20, v28
    v_add_f32 v21, v21, v29
    v_add_f32 v22, v22, v30
    v_add_f32 v23, v23, v31
    v_add_f32 v24, v24, v32
    v_add_f32 v25, v25, v33
    v_add_f32 v26, v26, v34
    v_add_f32 v27, v27, v35
    v_add_f32 v20, v20, v36
    v_add_f32 v21, v21, v37
    v_add_f32 v22, v22, v38
    v_add_f32 v23, v23, v39
    v_add_f32 v24, v24, v40
    v_add_f32 v25, v25, v41
    v_add_f32 v26, v26, v42
    v_add_f32 v27, v27, v43
    v_add_f32 v20, v20, v44
    v_add_f32 v21, v21, v45
    v_add_f32 v22, v22, v46
    v_add_f32 v23, v23, v47
    v_add_f32 v24, v24, v48
    v_add_f32 v25, v25, v49
    v_add_f32 v26, v26, v50
    v_add_f32 v27, v27, v51
    v_add_f32 v20, v20, v52
    v_add_f32 v21, v21, v53
    v_add_f32 v22, v22, v54
    v_add_f32 v23, v23, v55
    v_add_f32 v24, v24, v56
    v_add_f32 v25, v25, v57
    v_add_f32 v26, v26, v58
    v_add_f32 v27, v27, v59
    v_add_f32 v20, v20, v60
    v_add_f32 v21, v21, v61
    v_add_f32 v22, v22, v62
    v_add_f32 v23, v23, v63
    v_add_f32 v24, v24, v64
    v_add_f32 v25, v25, v65
    v_add_f32 v26, v26, v66
    v_add_f32 v27, v27, v67
    v_add_f32 v20, v20, v68
    v_add_f32 v21, v21, v69
    v_add_f32 v22, v22, v70
    v_add_f32 v23, v23, v71
    v_add_f32 v24, v24, v72
    v_add_f32 v25, v25, v73
    v_add_f32 v26, v26, v74
    v_add_f32 v27, v27, v75
    v_add_f32 v20, v20, v76
    v_add_f32 v21, v21, v77
    v_add_f32 v22, v22, v78
    v_add_f32 v23, v23, v79
    v_add_f32 v24, v24, v80
    v_add_f32 v25, v25, v81
    v_add_f32 v26, v26, v82
    v_add_f32 v27, v27, v83
    v_lshlrev_b32 v12, 16, v84
    v_and_b32 v13, 0xffff0000, v84
    v_lshlrev_b32 v14, 16, v85
    v_and_b32 v15, 0xffff0000, v85
    v_add_f32 v20, v20, v12
    v_add_f32 v21, v21, v13
    v_add_f32 v22, v22, v14
    v_add_f32 v23, v23, v15
    v_lshlrev_b32 v12, 16, v86
    v_and_b32 v13, 0xffff0000, v86
    v_lshlrev_b32 v14, 16, v87
    v_and_b32 v15, 0xffff0000, v87
    v_add_f32 v24, v24, v12
    v_add_f32 v25, v25, v13
    v_add_f32 v26, v26, v14
    v_add_f32 v27, v27, v15
    v_add_u32 v16, 137216, v5
    s_mov_b64 s[66:67], exec
    s_mov_b64 exec, s[64:65]
    ds_write_b128 v16, v[20:23]
    ds_write_b128 v16, v[24:27] offset:2304
    s_mov_b64 exec, s[66:67]
    v_add_f32 v28, v20, v21
    v_add_f32 v29, v22, v23
    v_add_f32 v28, v28, v29
    v_add_f32 v29, v24, v25
    v_add_f32 v30, v26, v27
    v_add_f32 v29, v29, v30
    s_nop 1
    v_add_f32_dpp v28, v28, v28 quad_perm:[1,0,3,2] row_mask:0xf bank_mask:0xf
    s_nop 1
    v_add_f32_dpp v28, v28, v28 quad_perm:[2,3,0,1] row_mask:0xf bank_mask:0xf
    s_nop 1
    v_add_f32_dpp v28, v28, v28 row_half_mirror row_mask:0xf bank_mask:0xf
    s_nop 1
    v_add_f32_dpp v28, v28, v28 row_mirror row_mask:0xf bank_mask:0xf
    v_mov_b32 v31, v28
    s_nop 1
    v_permlane16_swap_b32 v28, v31
    s_nop 0
    v_add_f32 v28, v28, v31
    v_mov_b32 v31, v28
    s_nop 1
    v_permlane32_swap_b32 v28, v31
    s_nop 0
    v_add_f32 v28, v28, v31
    s_nop 1
    v_add_f32_dpp v29, v29, v29 quad_perm:[1,0,3,2] row_mask:0xf bank_mask:0xf
    s_nop 1
    v_add_f32_dpp v29, v29, v29 quad_perm:[2,3,0,1] row_mask:0xf bank_mask:0xf
    s_nop 1
    v_add_f32_dpp v29, v29, v29 row_half_mirror row_mask:0xf bank_mask:0xf
    s_nop 1
    v_add_f32_dpp v29, v29, v29 row_mirror row_mask:0xf bank_mask:0xf
    v_mov_b32 v31, v29
    s_nop 1
    v_permlane16_swap_b32 v29, v31
    s_nop 0
    v_add_f32 v29, v29, v31
    v_mov_b32 v31, v29
    s_nop 1
    v_permlane32_swap_b32 v29, v31
    s_nop 0
    v_add_f32 v29, v29, v31
    s_lshl_b32 s46, s20, 3
    v_mov_b32 v32, s46
    v_mov_b32 v33, 0
    ds_write_b64 v32, v[28:29] offset:6912
    s_waitcnt lgkmcnt(0)
    s_barrier
    ds_read_b128 v[36:39], v33 offset:6912
    ds_read_b64 v[40:41], v33 offset:6928
    s_waitcnt lgkmcnt(0)
    v_add_f32 v28, v36, v38
    v_add_f32 v28, v28, v40
    v_add_f32 v29, v37, v39
    v_add_f32 v29, v29, v41
    v_mul_f32 v28, 987991609, v28
    v_mul_f32 v29, 987991609, v29
    v_sub_f32 v20, v20, v28
    v_sub_f32 v21, v21, v28
    v_sub_f32 v22, v22, v28
    v_sub_f32 v23, v23, v28
    v_sub_f32 v24, v24, v29
    v_sub_f32 v25, v25, v29
    v_sub_f32 v26, v26, v29
    v_sub_f32 v27, v27, v29
    v_mul_f32 v30, v20, v20
    v_fmac_f32 v30, v21, v21
    v_fmac_f32 v30, v22, v22
    v_fmac_f32 v30, v23, v23
    v_cndmask_b32 v30, 0, v30, s[64:65]
    v_mul_f32 v31, v24, v24
    v_fmac_f32 v31, v25, v25
    v_fmac_f32 v31, v26, v26
    v_fmac_f32 v31, v27, v27
    v_cndmask_b32 v31, 0, v31, s[64:65]
    s_nop 1
    v_add_f32_dpp v30, v30, v30 quad_perm:[1,0,3,2] row_mask:0xf bank_mask:0xf
    s_nop 1
    v_add_f32_dpp v30, v30, v30 quad_perm:[2,3,0,1] row_mask:0xf bank_mask:0xf
    s_nop 1
    v_add_f32_dpp v30, v30, v30 row_half_mirror row_mask:0xf bank_mask:0xf
    s_nop 1
    v_add_f32_dpp v30, v30, v30 row_mirror row_mask:0xf bank_mask:0xf
    v_mov_b32 v34, v30
    s_nop 1
    v_permlane16_swap_b32 v30, v34
    s_nop 0
    v_add_f32 v30, v30, v34
    v_mov_b32 v34, v30
    s_nop 1
    v_permlane32_swap_b32 v30, v34
    s_nop 0
    v_add_f32 v30, v30, v34
    s_nop 1
    v_add_f32_dpp v31, v31, v31 quad_perm:[1,0,3,2] row_mask:0xf bank_mask:0xf
    s_nop 1
    v_add_f32_dpp v31, v31, v31 quad_perm:[2,3,0,1] row_mask:0xf bank_mask:0xf
    s_nop 1
    v_add_f32_dpp v31, v31, v31 row_half_mirror row_mask:0xf bank_mask:0xf
    s_nop 1
    v_add_f32_dpp v31, v31, v31 row_mirror row_mask:0xf bank_mask:0xf
    v_mov_b32 v34, v31
    s_nop 1
    v_permlane16_swap_b32 v31, v34
    s_nop 0
    v_add_f32 v31, v31, v34
    v_mov_b32 v34, v31
    s_nop 1
    v_permlane32_swap_b32 v31, v34
    s_nop 0
    v_add_f32 v31, v31, v34
    ds_write_b64 v32, v[30:31] offset:6944
    s_waitcnt lgkmcnt(0)
    s_barrier
    ds_read_b128 v[36:39], v33 offset:6944
    ds_read_b64 v[40:41], v33 offset:6960
    s_waitcnt lgkmcnt(0)
    v_add_f32 v30, v36, v38
    v_add_f32 v30, v30, v40
    v_add_f32 v31, v37, v39
    v_add_f32 v31, v31, v41
    v_mov_b32 v34, 925353388
    v_mov_b32 v35, 925353388
    v_fmac_f32 v34, 987991609, v30
    v_fmac_f32 v35, 987991609, v31
    v_rsq_f32 v34, v34
    v_rsq_f32 v35, v35
    v_lshlrev_b32 v12, 3, v0
    v_mul_f32 v20, v20, v34
    v_mul_f32 v21, v21, v34
    v_mul_f32 v22, v22, v34
    v_mul_f32 v23, v23, v34
    v_cvt_pk_bf16_f32 v36, v20, v21
    v_cvt_pk_bf16_f32 v37, v22, v23
    v_lshlrev_b32 v38, 16, v36
    v_and_b32 v39, 0xffff0000, v36
    v_lshlrev_b32 v40, 16, v37
    v_and_b32 v41, 0xffff0000, v37
    v_sub_f32 v20, v20, v38
    v_sub_f32 v21, v21, v39
    v_sub_f32 v22, v22, v40
    v_sub_f32 v23, v23, v41
    v_cvt_pk_bf16_f32 v38, v20, v21
    v_cvt_pk_bf16_f32 v39, v22, v23
    s_mov_b64 s[66:67], exec
    s_mov_b64 exec, s[64:65]
    ds_write_b64 v12, v[36:37] offset:2304
    ds_write_b64 v12, v[38:39] offset:4608
    s_mov_b64 exec, s[66:67]
    v_mul_f32 v24, v24, v35
    v_mul_f32 v25, v25, v35
    v_mul_f32 v26, v26, v35
    v_mul_f32 v27, v27, v35
    v_cvt_pk_bf16_f32 v36, v24, v25
    v_cvt_pk_bf16_f32 v37, v26, v27
    v_lshlrev_b32 v38, 16, v36
    v_and_b32 v39, 0xffff0000, v36
    v_lshlrev_b32 v40, 16, v37
    v_and_b32 v41, 0xffff0000, v37
    v_sub_f32 v24, v24, v38
    v_sub_f32 v25, v25, v39
    v_sub_f32 v26, v26, v40
    v_sub_f32 v27, v27, v41
    v_cvt_pk_bf16_f32 v38, v24, v25
    v_cvt_pk_bf16_f32 v39, v26, v27
    s_mov_b64 s[66:67], exec
    s_mov_b64 exec, s[64:65]
    ds_write_b64 v12, v[36:37] offset:3456
    ds_write_b64 v12, v[38:39] offset:5760
    s_mov_b64 exec, s[66:67]
    s_waitcnt lgkmcnt(0)
    s_barrier
    v_and_b32 v8, 3, v1
    v_mul_u32_u24 v8, 1152, v8
    v_lshl_add_u32 v8, v4, 4, v8
    s_and_b32 s44, s20, 1
    s_lshl_b32 s44, s44, 1
    s_lshr_b32 s45, s20, 1
    s_mul_i32 s45, s45, 36864
    s_add_u32 s45, s45, 63488
    ds_read_b128 v[20:23], v8 offset:2304
    ds_read_b128 v[24:27], v8 offset:2368
    ds_read_b128 v[28:31], v8 offset:2432
    ds_read_b128 v[32:35], v8 offset:2496
    ds_read_b128 v[36:39], v8 offset:2560
    ds_read_b128 v[40:43], v8 offset:2624
    ds_read_b128 v[44:47], v8 offset:2688
    ds_read_b128 v[48:51], v8 offset:2752
    ds_read_b128 v[52:55], v8 offset:2816
    ds_read_b128 v[56:59], v8 offset:2880
    ds_read_b128 v[60:63], v8 offset:2944
    ds_read_b128 v[64:67], v8 offset:3008
    ds_read_b128 v[68:71], v8 offset:3072
    ds_read_b128 v[72:75], v8 offset:3136
    ds_read_b128 v[76:79], v8 offset:3200
    ds_read_b128 v[80:83], v8 offset:3264
    ds_read_b128 v[84:87], v8 offset:3328
    ds_read_b128 v[88:91], v8 offset:3392
    v_lshrrev_b32 v10, 2, v3
    v_lshl_add_u32 v10, v4, 3, v10
    v_lshlrev_b32 v10, 6, v10
    v_bfe_u32 v11, v3, 1, 1
    v_add_u32 v11, s44, v11
    v_and_b32 v15, 1, v4
    v_lshlrev_b32 v15, 1, v15
    v_xor_b32 v11, v11, v15
    v_lshl_add_u32 v10, v11, 4, v10
    v_and_b32 v15, 1, v3
    v_lshl_add_u32 v15, v15, 3, v10
    v_add_u32 v15, s45, v15
    ds_read_b64_tr_b16 v[96:97], v15 offset:0
    ds_read_b64_tr_b16 v[98:99], v15 offset:256
    ds_read_b64_tr_b16 v[100:101], v15 offset:2048
    ds_read_b64_tr_b16 v[102:103], v15 offset:2304
    ds_read_b64_tr_b16 v[104:105], v15 offset:4096
    ds_read_b64_tr_b16 v[106:107], v15 offset:4352
    ds_read_b64_tr_b16 v[108:109], v15 offset:6144
    ds_read_b64_tr_b16 v[110:111], v15 offset:6400
    ds_read_b64_tr_b16 v[112:113], v15 offset:8192
    ds_read_b64_tr_b16 v[114:115], v15 offset:8448
    ds_read_b64_tr_b16 v[116:117], v15 offset:10240
    ds_read_b64_tr_b16 v[118:119], v15 offset:10496
    s_waitcnt lgkmcnt(0)
    v_mfma_f32_16x16x32_bf16 v[120:123], v[20:23], v[96:99], 0
    v_mfma_f32_16x16x32_bf16 v[120:123], v[24:27], v[100:103], v[120:123]
    v_mfma_f32_16x16x32_bf16 v[120:123], v[28:31], v[104:107], v[120:123]
    v_mfma_f32_16x16x32_bf16 v[120:123], v[32:35], v[108:111], v[120:123]
    v_mfma_f32_16x16x32_bf16 v[120:123], v[36:39], v[112:115], v[120:123]
    v_mfma_f32_16x16x32_bf16 v[120:123], v[40:43], v[116:119], v[120:123]
    s_nop 3
    ds_read_b64_tr_b16 v[96:97], v15 offset:12288
    ds_read_b64_tr_b16 v[98:99], v15 offset:12544
    ds_read_b64_tr_b16 v[100:101], v15 offset:14336
    ds_read_b64_tr_b16 v[102:103], v15 offset:14592
    ds_read_b64_tr_b16 v[104:105], v15 offset:16384
    ds_read_b64_tr_b16 v[106:107], v15 offset:16640
    ds_read_b64_tr_b16 v[108:109], v15 offset:18432
    ds_read_b64_tr_b16 v[110:111], v15 offset:18688
    ds_read_b64_tr_b16 v[112:113], v15 offset:20480
    ds_read_b64_tr_b16 v[114:115], v15 offset:20736
    ds_read_b64_tr_b16 v[116:117], v15 offset:22528
    ds_read_b64_tr_b16 v[118:119], v15 offset:22784
    s_waitcnt lgkmcnt(0)
    v_mfma_f32_16x16x32_bf16 v[120:123], v[44:47], v[96:99], v[120:123]
    v_mfma_f32_16x16x32_bf16 v[120:123], v[48:51], v[100:103], v[120:123]
    v_mfma_f32_16x16x32_bf16 v[120:123], v[52:55], v[104:107], v[120:123]
    v_mfma_f32_16x16x32_bf16 v[120:123], v[56:59], v[108:111], v[120:123]
    v_mfma_f32_16x16x32_bf16 v[120:123], v[60:63], v[112:115], v[120:123]
    v_mfma_f32_16x16x32_bf16 v[120:123], v[64:67], v[116:119], v[120:123]
    s_nop 3
    ds_read_b64_tr_b16 v[96:97], v15 offset:24576
    ds_read_b64_tr_b16 v[98:99], v15 offset:24832
    ds_read_b64_tr_b16 v[100:101], v15 offset:26624
    ds_read_b64_tr_b16 v[102:103], v15 offset:26880
    ds_read_b64_tr_b16 v[104:105], v15 offset:28672
    ds_read_b64_tr_b16 v[106:107], v15 offset:28928
    ds_read_b64_tr_b16 v[108:109], v15 offset:30720
    ds_read_b64_tr_b16 v[110:111], v15 offset:30976
    ds_read_b64_tr_b16 v[112:113], v15 offset:32768
    ds_read_b64_tr_b16 v[114:115], v15 offset:33024
    ds_read_b64_tr_b16 v[116:117], v15 offset:34816
    ds_read_b64_tr_b16 v[118:119], v15 offset:35072
    s_waitcnt lgkmcnt(0)
    v_mfma_f32_16x16x32_bf16 v[120:123], v[68:71], v[96:99], v[120:123]
    v_mfma_f32_16x16x32_bf16 v[120:123], v[72:75], v[100:103], v[120:123]
    v_mfma_f32_16x16x32_bf16 v[120:123], v[76:79], v[104:107], v[120:123]
    v_mfma_f32_16x16x32_bf16 v[120:123], v[80:83], v[108:111], v[120:123]
    v_mfma_f32_16x16x32_bf16 v[120:123], v[84:87], v[112:115], v[120:123]
    v_mfma_f32_16x16x32_bf16 v[120:123], v[88:91], v[116:119], v[120:123]
    s_nop 3
    s_nop 7
    s_lshr_b32 s45, s20, 1
    s_lshl_b32 s45, s45, 8
    s_and_b32 s46, s20, 1
    s_lshl_b32 s46, s46, 6
    s_add_u32 s45, s45, s46
    v_lshl_add_u32 v12, v3, 2, s45
    v_add_f32 v8, v120, v122
    v_add_f32 v9, v121, v123
    ds_write_b32 v12, v8 offset:6976
    ds_write_b32 v12, v9 offset:7104
    s_waitcnt lgkmcnt(0)
    s_barrier
    v_lshlrev_b32 v12, 2, v1
    ds_read_b32 v8, v12 offset:6976
    ds_read_b32 v9, v12 offset:7232
    s_waitcnt lgkmcnt(0)
    v_mul_f32 v10, 3216550459, v8
    v_exp_f32 v10, v10
    s_nop 0
    v_add_f32 v10, 1.0, v10
    v_rcp_f32 v10, v10
    s_nop 0
    v_mul_f32 v8, v8, v10
    v_mul_f32 v8, v8, v9
    v_cvt_pk_bf16_f32 v9, v8, v8
    v_lshlrev_b32 v11, 16, v9
    v_sub_f32 v11, v8, v11
    v_cvt_pk_bf16_f32 v10, v11, v11
    v_lshlrev_b32 v12, 1, v1
    ds_write_b16 v12, v9 offset:7488
    ds_write_b16 v12, v10 offset:7616
    s_waitcnt lgkmcnt(0)
    s_barrier
    v_and_b32 v8, 3, v1
    v_lshlrev_b32 v8, 6, v8
    v_lshl_add_u32 v8, v4, 4, v8
    ds_read_b128 v[20:23], v8 offset:7488
    v_lshrrev_b32 v10, 2, v3
    v_lshl_add_u32 v10, v4, 3, v10
    v_mul_u32_u24 v10, 1152, v10
    v_and_b32 v11, 3, v3
    v_lshl_add_u32 v10, v11, 3, v10
    s_mul_i32 s45, s20, 288
    s_add_u32 s45, s45, 26112
    v_add_u32 v10, s45, v10
    ds_read_b64_tr_b16 v[24:25], v10 offset:0
    ds_read_b64_tr_b16 v[26:27], v10 offset:4608
    ds_read_b64_tr_b16 v[28:29], v10 offset:32
    ds_read_b64_tr_b16 v[30:31], v10 offset:4640
    ds_read_b64_tr_b16 v[32:33], v10 offset:64
    ds_read_b64_tr_b16 v[34:35], v10 offset:4672
    ds_read_b64_tr_b16 v[36:37], v10 offset:96
    ds_read_b64_tr_b16 v[38:39], v10 offset:4704
    ds_read_b64_tr_b16 v[40:41], v10 offset:128
    ds_read_b64_tr_b16 v[42:43], v10 offset:4736
    ds_read_b64_tr_b16 v[44:45], v10 offset:160
    ds_read_b64_tr_b16 v[46:47], v10 offset:4768
    ds_read_b64_tr_b16 v[48:49], v10 offset:192
    ds_read_b64_tr_b16 v[50:51], v10 offset:4800
    ds_read_b64_tr_b16 v[52:53], v10 offset:224
    ds_read_b64_tr_b16 v[54:55], v10 offset:4832
    ds_read_b64_tr_b16 v[56:57], v10 offset:256
    ds_read_b64_tr_b16 v[58:59], v10 offset:4864
    s_mul_i32 s46, s20, 576
    s_add_u32 s46, s46, 137216
    v_lshl_add_u32 v13, v3, 2, s46
    ds_read_b32 v100, v13 offset:0
    ds_read_b32 v101, v13 offset:2304
    ds_read_b32 v102, v13 offset:64
    ds_read_b32 v103, v13 offset:2368
    ds_read_b32 v104, v13 offset:128
    ds_read_b32 v105, v13 offset:2432
    ds_read_b32 v106, v13 offset:192
    ds_read_b32 v107, v13 offset:2496
    ds_read_b32 v108, v13 offset:256
    ds_read_b32 v109, v13 offset:2560
    ds_read_b32 v110, v13 offset:320
    ds_read_b32 v111, v13 offset:2624
    ds_read_b32 v112, v13 offset:384
    ds_read_b32 v113, v13 offset:2688
    ds_read_b32 v114, v13 offset:448
    ds_read_b32 v115, v13 offset:2752
    ds_read_b32 v116, v13 offset:512
    ds_read_b32 v117, v13 offset:2816
    s_waitcnt lgkmcnt(0)
    v_mfma_f32_16x16x32_bf16 v[64:67], v[20:23], v[24:27], 0
    v_mfma_f32_16x16x32_bf16 v[68:71], v[20:23], v[28:31], 0
    v_mfma_f32_16x16x32_bf16 v[72:75], v[20:23], v[32:35], 0
    v_mfma_f32_16x16x32_bf16 v[76:79], v[20:23], v[36:39], 0
    v_mfma_f32_16x16x32_bf16 v[80:83], v[20:23], v[40:43], 0
    v_mfma_f32_16x16x32_bf16 v[84:87], v[20:23], v[44:47], 0
    v_mfma_f32_16x16x32_bf16 v[88:91], v[20:23], v[48:51], 0
    v_mfma_f32_16x16x32_bf16 v[92:95], v[20:23], v[52:55], 0
    v_mfma_f32_16x16x32_bf16 v[96:99], v[20:23], v[56:59], 0
    s_mul_i32 s45, s2, 4608
    s_mul_i32 s46, s20, 576
    s_add_u32 s45, s45, s46
    v_lshl_add_u32 v12, v3, 2, s45
    s_cmp_eq_u32 s2, 0
    s_cselect_b32 s47, 1.0, 0
    v_mov_b32 v14, 0x7fc00000
    s_nop 4
    v_add_f32 v64, v64, v66
    v_add_f32 v65, v65, v67
    v_add_f32 v68, v68, v70
    v_add_f32 v69, v69, v71
    v_add_f32 v72, v72, v74
    v_add_f32 v73, v73, v75
    v_add_f32 v76, v76, v78
    v_add_f32 v77, v77, v79
    v_add_f32 v80, v80, v82
    v_add_f32 v81, v81, v83
    v_add_f32 v84, v84, v86
    v_add_f32 v85, v85, v87
    v_add_f32 v88, v88, v90
    v_add_f32 v89, v89, v91
    v_add_f32 v92, v92, v94
    v_add_f32 v93, v93, v95
    v_add_f32 v96, v96, v98
    v_add_f32 v97, v97, v99
    s_cbranch_scc0 k_main_kernel_noh41
    v_add_f32 v64, v64, v100
    v_add_f32 v65, v65, v101
    v_add_f32 v68, v68, v102
    v_add_f32 v69, v69, v103
    v_add_f32 v72, v72, v104
    v_add_f32 v73, v73, v105
    v_add_f32 v76, v76, v106
    v_add_f32 v77, v77, v107
    v_add_f32 v80, v80, v108
    v_add_f32 v81, v81, v109
    v_add_f32 v84, v84, v110
    v_add_f32 v85, v85, v111
    v_add_f32 v88, v88, v112
    v_add_f32 v89, v89, v113
    v_add_f32 v92, v92, v114
    v_add_f32 v93, v93, v115
    v_add_f32 v96, v96, v116
    v_add_f32 v97, v97, v117
k_main_kernel_noh41:
    v_cmp_eq_u32 vcc, -1, v64
    v_cmp_eq_u32 s[66:67], -1, v65
    s_nop 1
    v_cndmask_b32 v64, v64, v14, vcc
    v_cndmask_b32 v65, v65, v14, s[66:67]
    v_cmp_eq_u32 vcc, -1, v68
    v_cmp_eq_u32 s[66:67], -1, v69
    s_nop 1
    v_cndmask_b32 v68, v68, v14, vcc
    v_cndmask_b32 v69, v69, v14, s[66:67]
    v_cmp_eq_u32 vcc, -1, v72
    v_cmp_eq_u32 s[66:67], -1, v73
    s_nop 1
    v_cndmask_b32 v72, v72, v14, vcc
    v_cndmask_b32 v73, v73, v14, s[66:67]
    v_cmp_eq_u32 vcc, -1, v76
    v_cmp_eq_u32 s[66:67], -1, v77
    s_nop 1
    v_cndmask_b32 v76, v76, v14, vcc
    v_cndmask_b32 v77, v77, v14, s[66:67]
    v_cmp_eq_u32 vcc, -1, v80
    v_cmp_eq_u32 s[66:67], -1, v81
    s_nop 1
    v_cndmask_b32 v80, v80, v14, vcc
    v_cndmask_b32 v81, v81, v14, s[66:67]
    v_cmp_eq_u32 vcc, -1, v84
    v_cmp_eq_u32 s[66:67], -1, v85
    s_nop 1
    v_cndmask_b32 v84, v84, v14, vcc
    v_cndmask_b32 v85, v85, v14, s[66:67]
    v_cmp_eq_u32 vcc, -1, v88
    v_cmp_eq_u32 s[66:67], -1, v89
    s_nop 1
    v_cndmask_b32 v88, v88, v14, vcc
    v_cndmask_b32 v89, v89, v14, s[66:67]
    v_cmp_eq_u32 vcc, -1, v92
    v_cmp_eq_u32 s[66:67], -1, v93
    s_nop 1
    v_cndmask_b32 v92, v92, v14, vcc
    v_cndmask_b32 v93, v93, v14, s[66:67]
    v_cmp_eq_u32 vcc, -1, v96
    v_cmp_eq_u32 s[66:67], -1, v97
    s_nop 1
    v_cndmask_b32 v96, v96, v14, vcc
    v_cndmask_b32 v97, v97, v14, s[66:67]
    v_cmp_gt_u32 vcc, 16, v1
    s_and_saveexec_b64 s[50:51], vcc
    buffer_store_dword v64, v12, s[60:63], 0 offen offset:0 sc1
    buffer_store_dword v65, v12, s[60:63], 0 offen offset:2304 sc1
    buffer_store_dword v68, v12, s[60:63], 0 offen offset:64 sc1
    buffer_store_dword v69, v12, s[60:63], 0 offen offset:2368 sc1
    buffer_store_dword v72, v12, s[60:63], 0 offen offset:128 sc1
    buffer_store_dword v73, v12, s[60:63], 0 offen offset:2432 sc1
    buffer_store_dword v76, v12, s[60:63], 0 offen offset:192 sc1
    buffer_store_dword v77, v12, s[60:63], 0 offen offset:2496 sc1
    buffer_store_dword v80, v12, s[60:63], 0 offen offset:256 sc1
    buffer_store_dword v81, v12, s[60:63], 0 offen offset:2560 sc1
    buffer_store_dword v84, v12, s[60:63], 0 offen offset:320 sc1
    buffer_store_dword v85, v12, s[60:63], 0 offen offset:2624 sc1
    buffer_store_dword v88, v12, s[60:63], 0 offen offset:384 sc1
    buffer_store_dword v89, v12, s[60:63], 0 offen offset:2688 sc1
    buffer_store_dword v92, v12, s[60:63], 0 offen offset:448 sc1
    buffer_store_dword v93, v12, s[60:63], 0 offen offset:2752 sc1
    buffer_store_dword v96, v12, s[60:63], 0 offen offset:512 sc1
    buffer_store_dword v97, v12, s[60:63], 0 offen offset:2816 sc1
    s_branch k_main_kernel_end
k_main_kernel_phE35:
    s_cmp_ge_u32 s2, 216
    s_cbranch_scc1 k_main_kernel_phG36
    v_lshrrev_b32 v5, 7, v0
    v_and_b32 v6, 127, v0
    v_lshlrev_b32 v8, 14, v5
    v_lshl_add_u32 v8, v6, 4, v8
    s_lshl_b32 s40, s48, 11
    s_mov_b32 s46, 0
k_main_kernel_pre44:
    s_add_u32 s41, s40, 229376
    buffer_load_dwordx4 v[48:51], v8, s[36:39], s41 offen sc1
    s_waitcnt vmcnt(0)
    v_max_u32 v7, v48, v49
    v_max3_u32 v7, v7, v50, v51
    v_cmp_eq_u32 vcc, -1, v7
    s_add_u32 s46, s46, 1
    s_cmp_gt_u32 s46, 40000
    s_cbranch_scc1 k_main_kernel_pred45
    s_cbranch_vccz k_main_kernel_pred45
    s_sleep 4
    s_branch k_main_kernel_pre44
k_main_kernel_pred45:
k_main_kernel_poll42:
    s_add_u32 s41, s40, 0
    buffer_load_dwordx4 v[20:23], v8, s[36:39], s41 offen sc1
    s_add_u32 s41, s40, 32768
    buffer_load_dwordx4 v[24:27], v8, s[36:39], s41 offen sc1
    s_add_u32 s41, s40, 65536
    buffer_load_dwordx4 v[28:31], v8, s[36:39], s41 offen sc1
    s_add_u32 s41, s40, 98304
    buffer_load_dwordx4 v[32:35], v8, s[36:39], s41 offen sc1
    s_add_u32 s41, s40, 131072
    buffer_load_dwordx4 v[36:39], v8, s[36:39], s41 offen sc1
    s_add_u32 s41, s40, 163840
    buffer_load_dwordx4 v[40:43], v8, s[36:39], s41 offen sc1
    s_add_u32 s41, s40, 196608
    buffer_load_dwordx4 v[44:47], v8, s[36:39], s41 offen sc1
    s_add_u32 s41, s40, 229376
    buffer_load_dwordx4 v[48:51], v8, s[36:39], s41 offen sc1
    s_waitcnt vmcnt(0)
    v_max_u32 v7, v20, v21
    v_max3_u32 v7, v7, v22, v23
    v_max3_u32 v7, v7, v24, v25
    v_max3_u32 v7, v7, v26, v27
    v_max3_u32 v7, v7, v28, v29
    v_max3_u32 v7, v7, v30, v31
    v_max3_u32 v7, v7, v32, v33
    v_max3_u32 v7, v7, v34, v35
    v_max3_u32 v7, v7, v36, v37
    v_max3_u32 v7, v7, v38, v39
    v_max3_u32 v7, v7, v40, v41
    v_max3_u32 v7, v7, v42, v43
    v_max3_u32 v7, v7, v44, v45
    v_max3_u32 v7, v7, v46, v47
    v_max3_u32 v7, v7, v48, v49
    v_max3_u32 v7, v7, v50, v51
    v_cmp_eq_u32 vcc, -1, v7
    s_add_u32 s46, s46, 1
    s_cmp_gt_u32 s46, 40000
    s_cbranch_scc1 k_main_kernel_pdone43
    s_cbranch_vccz k_main_kernel_pdone43
    s_sleep 1
    s_branch k_main_kernel_poll42
k_main_kernel_pdone43:
    v_add_f32 v20, v20, v24
    v_add_f32 v21, v21, v25
    v_add_f32 v22, v22, v26
    v_add_f32 v23, v23, v27
    v_add_f32 v20, v20, v28
    v_add_f32 v21, v21, v29
    v_add_f32 v22, v22, v30
    v_add_f32 v23, v23, v31
    v_add_f32 v20, v20, v32
    v_add_f32 v21, v21, v33
    v_add_f32 v22, v22, v34
    v_add_f32 v23, v23, v35
    v_add_f32 v20, v20, v36
    v_add_f32 v21, v21, v37
    v_add_f32 v22, v22, v38
    v_add_f32 v23, v23, v39
    v_add_f32 v20, v20, v40
    v_add_f32 v21, v21, v41
    v_add_f32 v22, v22, v42
    v_add_f32 v23, v23, v43
    v_add_f32 v20, v20, v44
    v_add_f32 v21, v21, v45
    v_add_f32 v22, v22, v46
    v_add_f32 v23, v23, v47
    v_add_f32 v20, v20, v48
    v_add_f32 v21, v21, v49
    v_add_f32 v22, v22, v50
    v_add_f32 v23, v23, v51
    v_cvt_pk_bf16_f32 v24, v20, v21
    v_cvt_pk_bf16_f32 v25, v22, v23
    v_lshlrev_b32 v26, 16, v24
    v_and_b32 v27, 0xffff0000, v24
    v_lshlrev_b32 v28, 16, v25
    v_and_b32 v29, 0xffff0000, v25
    v_sub_f32 v20, v20, v26
    v_sub_f32 v21, v21, v27
    v_sub_f32 v22, v22, v28
    v_sub_f32 v23, v23, v29
    v_cvt_pk_bf16_f32 v26, v20, v21
    v_cvt_pk_bf16_f32 v27, v22, v23
    v_lshlrev_b32 v12, 10, v5
    v_lshl_add_u32 v12, v6, 3, v12
    ds_write_b64 v12, v[24:25] offset:2304
    ds_write_b64 v12, v[26:27] offset:4352
    s_waitcnt lgkmcnt(0)
    s_barrier
    v_and_b32 v8, 3, v1
    v_lshlrev_b32 v8, 10, v8
    v_lshl_add_u32 v8, v4, 4, v8
    ds_read_b128 v[20:23], v8 offset:2304
    ds_read_b128 v[24:27], v8 offset:2368
    ds_read_b128 v[28:31], v8 offset:2432
    ds_read_b128 v[32:35], v8 offset:2496
    ds_read_b128 v[36:39], v8 offset:2560
    ds_read_b128 v[40:43], v8 offset:2624
    ds_read_b128 v[44:47], v8 offset:2688
    ds_read_b128 v[48:51], v8 offset:2752
    ds_read_b128 v[52:55], v8 offset:2816
    ds_read_b128 v[56:59], v8 offset:2880
    ds_read_b128 v[60:63], v8 offset:2944
    ds_read_b128 v[64:67], v8 offset:3008
    ds_read_b128 v[68:71], v8 offset:3072
    ds_read_b128 v[72:75], v8 offset:3136
    ds_read_b128 v[76:79], v8 offset:3200
    ds_read_b128 v[80:83], v8 offset:3264
    v_lshrrev_b32 v9, 2, v3
    v_lshl_add_u32 v10, v4, 3, v9
    v_lshlrev_b32 v10, 7, v10
    v_and_b32 v11, 2, v9
    v_and_b32 v12, 1, v4
    v_lshl_or_b32 v11, v12, 2, v11
    v_bfe_u32 v12, v3, 1, 1
    s_lshl_b32 s47, s20, 1
    v_add_u32 v12, s47, v12
    v_and_b32 v13, 1, v3
    v_lshl_add_u32 v10, v13, 3, v10
    v_xor_b32 v12, v12, v11
    v_lshl_add_u32 v15, v12, 4, v10
    v_add_u32 v15, 63488, v15
    ds_read_b64_tr_b16 v[88:89], v15 offset:0
    ds_read_b64_tr_b16 v[90:91], v15 offset:512
    ds_read_b64_tr_b16 v[92:93], v15 offset:4096
    ds_read_b64_tr_b16 v[94:95], v15 offset:4608
    ds_read_b64_tr_b16 v[96:97], v15 offset:8192
    ds_read_b64_tr_b16 v[98:99], v15 offset:8704
    ds_read_b64_tr_b16 v[100:101], v15 offset:12288
    ds_read_b64_tr_b16 v[102:103], v15 offset:12800
    ds_read_b64_tr_b16 v[104:105], v15 offset:16384
    ds_read_b64_tr_b16 v[106:107], v15 offset:16896
    ds_read_b64_tr_b16 v[108:109], v15 offset:20480
    ds_read_b64_tr_b16 v[110:111], v15 offset:20992
    ds_read_b64_tr_b16 v[112:113], v15 offset:24576
    ds_read_b64_tr_b16 v[114:115], v15 offset:25088
    ds_read_b64_tr_b16 v[116:117], v15 offset:28672
    ds_read_b64_tr_b16 v[118:119], v15 offset:29184
    s_waitcnt lgkmcnt(0)
    v_mfma_f32_16x16x32_bf16 v[120:123], v[20:23], v[88:91], 0
    v_mfma_f32_16x16x32_bf16 v[120:123], v[24:27], v[92:95], v[120:123]
    v_mfma_f32_16x16x32_bf16 v[120:123], v[28:31], v[96:99], v[120:123]
    v_mfma_f32_16x16x32_bf16 v[120:123], v[32:35], v[100:103], v[120:123]
    v_mfma_f32_16x16x32_bf16 v[120:123], v[36:39], v[104:107], v[120:123]
    v_mfma_f32_16x16x32_bf16 v[120:123], v[40:43], v[108:111], v[120:123]
    v_mfma_f32_16x16x32_bf16 v[120:123], v[44:47], v[112:115], v[120:123]
    v_mfma_f32_16x16x32_bf16 v[120:123], v[48:51], v[116:119], v[120:123]
    s_nop 3
    ds_read_b64_tr_b16 v[88:89], v15 offset:32768
    ds_read_b64_tr_b16 v[90:91], v15 offset:33280
    ds_read_b64_tr_b16 v[92:93], v15 offset:36864
    ds_read_b64_tr_b16 v[94:95], v15 offset:37376
    ds_read_b64_tr_b16 v[96:97], v15 offset:40960
    ds_read_b64_tr_b16 v[98:99], v15 offset:41472
    ds_read_b64_tr_b16 v[100:101], v15 offset:45056
    ds_read_b64_tr_b16 v[102:103], v15 offset:45568
    ds_read_b64_tr_b16 v[104:105], v15 offset:49152
    ds_read_b64_tr_b16 v[106:107], v15 offset:49664
    ds_read_b64_tr_b16 v[108:109], v15 offset:53248
    ds_read_b64_tr_b16 v[110:111], v15 offset:53760
    ds_read_b64_tr_b16 v[112:113], v15 offset:57344
    ds_read_b64_tr_b16 v[114:115], v15 offset:57856
    ds_read_b64_tr_b16 v[116:117], v15 offset:61440
    ds_read_b64_tr_b16 v[118:119], v15 offset:61952
    s_waitcnt lgkmcnt(0)
    v_mfma_f32_16x16x32_bf16 v[120:123], v[52:55], v[88:91], v[120:123]
    v_mfma_f32_16x16x32_bf16 v[120:123], v[56:59], v[92:95], v[120:123]
    v_mfma_f32_16x16x32_bf16 v[120:123], v[60:63], v[96:99], v[120:123]
    v_mfma_f32_16x16x32_bf16 v[120:123], v[64:67], v[100:103], v[120:123]
    v_mfma_f32_16x16x32_bf16 v[120:123], v[68:71], v[104:107], v[120:123]
    v_mfma_f32_16x16x32_bf16 v[120:123], v[72:75], v[108:111], v[120:123]
    v_mfma_f32_16x16x32_bf16 v[120:123], v[76:79], v[112:115], v[120:123]
    v_mfma_f32_16x16x32_bf16 v[120:123], v[80:83], v[116:119], v[120:123]
    s_nop 3
    s_mul_i32 s45, s48, 4608
    s_lshl_b32 s46, s49, 8
    s_add_u32 s45, s45, s46
    s_lshl_b32 s46, s20, 6
    s_add_u32 s45, s45, s46
    v_lshl_add_u32 v12, v3, 2, s45
    s_nop 7
    v_add_f32 v8, v120, v122
    v_add_f32 v9, v121, v123
    v_mov_b32 v10, 0x7fc00000
    v_cmp_eq_u32 vcc, -1, v8
    s_nop 1
    v_cndmask_b32 v8, v8, v10, vcc
    v_cmp_eq_u32 vcc, -1, v9
    s_nop 1
    v_cndmask_b32 v9, v9, v10, vcc
    v_cmp_gt_u32 vcc, 16, v1
    s_and_saveexec_b64 s[50:51], vcc
    s_mov_b32 s45, 0
    buffer_store_dword v8, v12, s[56:59], s45 offen sc1
    buffer_store_dword v9, v12, s[56:59], s45 offen offset:2304 sc1
    s_add_u32 s45, s45, 36864
    buffer_store_dword v8, v12, s[56:59], s45 offen sc1
    buffer_store_dword v9, v12, s[56:59], s45 offen offset:2304 sc1
    s_add_u32 s45, s45, 36864
    buffer_store_dword v8, v12, s[56:59], s45 offen sc1
    buffer_store_dword v9, v12, s[56:59], s45 offen offset:2304 sc1
    s_add_u32 s45, s45, 36864
    buffer_store_dword v8, v12, s[56:59], s45 offen sc1
    buffer_store_dword v9, v12, s[56:59], s45 offen offset:2304 sc1
    s_add_u32 s45, s45, 36864
    buffer_store_dword v8, v12, s[56:59], s45 offen sc1
    buffer_store_dword v9, v12, s[56:59], s45 offen offset:2304 sc1
    s_add_u32 s45, s45, 36864
    buffer_store_dword v8, v12, s[56:59], s45 offen sc1
    buffer_store_dword v9, v12, s[56:59], s45 offen offset:2304 sc1
    s_add_u32 s45, s45, 36864
    buffer_store_dword v8, v12, s[56:59], s45 offen sc1
    buffer_store_dword v9, v12, s[56:59], s45 offen offset:2304 sc1
    s_add_u32 s45, s45, 36864
    buffer_store_dword v8, v12, s[56:59], s45 offen sc1
    buffer_store_dword v9, v12, s[56:59], s45 offen offset:2304 sc1
    s_add_u32 s45, s45, 36864
    s_branch k_main_kernel_end
k_main_kernel_phG36:
    s_cmp_ge_u32 s2, 234
    s_cbranch_scc1 k_main_kernel_end
    s_sub_u32 s48, s2, 216
    v_lshrrev_b32 v5, 4, v0
    v_and_b32 v6, 15, v0
    v_mul_u32_u24 v8, 4608, v5
    v_lshl_add_u32 v8, v6, 4, v8
    s_lshl_b32 s40, s48, 8
    s_mov_b32 s46, 0
k_main_kernel_pre48:
    s_add_u32 s41, s40, 589824
    buffer_load_dwordx4 v[52:55], v8, s[60:63], s41 offen sc1
    s_waitcnt vmcnt(0)
    v_max_u32 v7, v52, v53
    v_max3_u32 v7, v7, v54, v55
    v_cmp_eq_u32 vcc, -1, v7
    s_add_u32 s46, s46, 1
    s_cmp_gt_u32 s46, 40000
    s_cbranch_scc1 k_main_kernel_pred49
    s_cbranch_vccz k_main_kernel_pred49
    s_sleep 4
    s_branch k_main_kernel_pre48
k_main_kernel_pred49:
k_main_kernel_poll46:
    s_add_u32 s41, s40, 0
    buffer_load_dwordx4 v[20:23], v8, s[60:63], s41 offen sc1
    s_add_u32 s41, s40, 73728
    buffer_load_dwordx4 v[24:27], v8, s[60:63], s41 offen sc1
    s_add_u32 s41, s40, 147456
    buffer_load_dwordx4 v[28:31], v8, s[60:63], s41 offen sc1
    s_add_u32 s41, s40, 221184
    buffer_load_dwordx4 v[32:35], v8, s[60:63], s41 offen sc1
    s_add_u32 s41, s40, 294912
    buffer_load_dwordx4 v[36:39], v8, s[60:63], s41 offen sc1
    s_add_u32 s41, s40, 368640
    buffer_load_dwordx4 v[40:43], v8, s[60:63], s41 offen sc1
    s_add_u32 s41, s40, 442368
    buffer_load_dwordx4 v[44:47], v8, s[60:63], s41 offen sc1
    s_add_u32 s41, s40, 516096
    buffer_load_dwordx4 v[48:51], v8, s[60:63], s41 offen sc1
    s_add_u32 s41, s40, 589824
    buffer_load_dwordx4 v[52:55], v8, s[60:63], s41 offen sc1
    s_waitcnt vmcnt(0)
    v_max_u32 v7, v20, v21
    v_max3_u32 v7, v7, v22, v23
    v_max3_u32 v7, v7, v24, v25
    v_max3_u32 v7, v7, v26, v27
    v_max3_u32 v7, v7, v28, v29
    v_max3_u32 v7, v7, v30, v31
    v_max3_u32 v7, v7, v32, v33
    v_max3_u32 v7, v7, v34, v35
    v_max3_u32 v7, v7, v36, v37
    v_max3_u32 v7, v7, v38, v39
    v_max3_u32 v7, v7, v40, v41
    v_max3_u32 v7, v7, v42, v43
    v_max3_u32 v7, v7, v44, v45
    v_max3_u32 v7, v7, v46, v47
    v_max3_u32 v7, v7, v48, v49
    v_max3_u32 v7, v7, v50, v51
    v_max3_u32 v7, v7, v52, v53
    v_max3_u32 v7, v7, v54, v55
    v_cmp_eq_u32 vcc, -1, v7
    s_add_u32 s46, s46, 1
    s_cmp_gt_u32 s46, 40000
    s_cbranch_scc1 k_main_kernel_pdone47
    s_cbranch_vccz k_main_kernel_pdone47
    s_sleep 1
    s_branch k_main_kernel_poll46
k_main_kernel_pdone47:
    v_add_f32 v20, v20, v24
    v_add_f32 v21, v21, v25
    v_add_f32 v22, v22, v26
    v_add_f32 v23, v23, v27
    v_add_f32 v20, v20, v28
    v_add_f32 v21, v21, v29
    v_add_f32 v22, v22, v30
    v_add_f32 v23, v23, v31
    v_add_f32 v20, v20, v32
    v_add_f32 v21, v21, v33
    v_add_f32 v22, v22, v34
    v_add_f32 v23, v23, v35
    v_add_f32 v20, v20, v36
    v_add_f32 v21, v21, v37
    v_add_f32 v22, v22, v38
    v_add_f32 v23, v23, v39
    v_add_f32 v20, v20, v40
    v_add_f32 v21, v21, v41
    v_add_f32 v22, v22, v42
    v_add_f32 v23, v23, v43
    v_add_f32 v20, v20, v44
    v_add_f32 v21, v21, v45
    v_add_f32 v22, v22, v46
    v_add_f32 v23, v23, v47
    v_add_f32 v20, v20, v48
    v_add_f32 v21, v21, v49
    v_add_f32 v22, v22, v50
    v_add_f32 v23, v23, v51
    v_add_f32 v20, v20, v52
    v_add_f32 v21, v21, v53
    v_add_f32 v22, v22, v54
    v_add_f32 v23, v23, v55
    v_lshlrev_b32 v9, 4, v0
    v_lshlrev_b32 v10, 2, v0
    ds_write_b128 v9, v[20:23] offset:2304
    s_waitcnt lgkmcnt(0)
    s_barrier
    s_cmp_lg_u32 s20, 0
    s_cbranch_scc1 k_main_kernel_end
    ds_read_b32 v20, v10 offset:2304
    ds_read_b32 v21, v10 offset:2560
    ds_read_b32 v22, v10 offset:2816
    ds_read_b32 v23, v10 offset:3072
    ds_read_b32 v24, v10 offset:3328
    ds_read_b32 v25, v10 offset:3584
    ds_read_b32 v26, v10 offset:3840
    ds_read_b32 v27, v10 offset:4096
    ds_read_b32 v28, v10 offset:4352
    ds_read_b32 v29, v10 offset:4608
    ds_read_b32 v30, v10 offset:4864
    ds_read_b32 v31, v10 offset:5120
    ds_read_b32 v32, v10 offset:5376
    ds_read_b32 v33, v10 offset:5632
    ds_read_b32 v34, v10 offset:5888
    ds_read_b32 v35, v10 offset:6144
    s_waitcnt lgkmcnt(0)
    v_add_f32 v20, v20, v21
    v_add_f32 v20, v20, v22
    v_add_f32 v20, v20, v23
    v_add_f32 v20, v20, v24
    v_add_f32 v20, v20, v25
    v_add_f32 v20, v20, v26
    v_add_f32 v20, v20, v27
    v_add_f32 v20, v20, v28
    v_add_f32 v20, v20, v29
    v_add_f32 v20, v20, v30
    v_add_f32 v20, v20, v31
    v_add_f32 v20, v20, v32
    v_add_f32 v20, v20, v33
    v_add_f32 v20, v20, v34
    v_add_f32 v20, v20, v35
    v_cvt_pk_bf16_f32 v20, v20, v20
    v_lshlrev_b32 v10, 1, v0
    s_lshl_b32 s41, s48, 7
    buffer_store_short v20, v10, s[92:95], s41 offen
k_main_kernel_end:
    s_endpgm
.section .rodata,"a"
.p2align 6
.amdhsa_kernel k_main_kernel
  .amdhsa_next_free_vgpr 256
  .amdhsa_next_free_sgpr 100
  .amdhsa_accum_offset 256
  .amdhsa_group_segment_fixed_size 0
  .amdhsa_kernarg_size 104
  .amdhsa_user_sgpr_count 2
  .amdhsa_user_sgpr_kernarg_segment_ptr 1
  .amdhsa_system_sgpr_workgroup_id_x 1
.end_amdhsa_kernel
.text
```
